```python
import torch

def _softmax(x, axis=-1):
    return torch.softmax(x, dim=axis)
def _gelu(x):
    return torch.nn.functional.gelu(x, approximate="tanh")
def _silu(x):
    return torch.nn.functional.silu(x)
def _sigmoid(x):
    return torch.sigmoid(x)
def _layernorm(x, axis=-1, eps=1e-5):
    m = x.mean(dim=axis, keepdim=True)
    v = x.var(dim=axis, keepdim=True, unbiased=False)
    return (x - m) / torch.sqrt(v + eps)
def _scatter_add(tgt, idx, src, axis=0):
    return tgt.clone().index_add_(axis, idx, src)
def _segment_sum(src, seg, n):
    out = torch.zeros((n,) + src.shape[1:], dtype=src.dtype)
    return out.index_add_(0, seg, src)
def _pad(x, pw):
    flat = tuple(v for pair in reversed(pw) for v in pair)
    return torch.nn.functional.pad(x, flat)

kernel_name = 'sequential_preLN__sliding_block__glu_gated_bilinear__prompt'

def setup_inputs():

    _w = (lambda a: (lambda t: t.to(torch.bfloat16) if t.is_floating_point() else t)(torch.as_tensor(a)))
    def _A_setup():
        B, S, D = 1, 2048, 640
        return {
            "x": _w((lambda *s: torch.randn(*s, dtype=torch.bfloat16) * 0.05)(B, S, D)),
            "wqkv": _w((lambda *s: torch.randn(*s, dtype=torch.bfloat16) * 0.05)(D, 3 * D)),
            "wo": _w((lambda *s: torch.randn(*s, dtype=torch.bfloat16) * 0.05)(D, D)),
        }
    _A_in = _A_setup()

    def _B_setup():
        B, S, D, F = 1, 2048, 640, 1536
        return {
            "x": _w((lambda *s: torch.randn(*s, dtype=torch.bfloat16) * 0.05)(B, S, D)),
            "w_gate": _w((lambda *s: torch.randn(*s, dtype=torch.bfloat16) * 0.8)(D, F) * (D ** -0.5)),
            "w_up": _w((lambda *s: torch.randn(*s, dtype=torch.bfloat16) * 0.8)(D, F) * (D ** -0.5)),
            "w_down": _w((lambda *s: torch.randn(*s, dtype=torch.bfloat16) * 0.8)(F, D) * (F ** -0.5)),
        }
    _B_in = _B_setup()

    return {
        "A_x": _A_in["x"],
        "A_wqkv": _A_in["wqkv"],
        "A_wo": _A_in["wo"],
        "B_x": _B_in["x"],
        "B_w_gate": _B_in["w_gate"],
        "B_w_up": _B_in["w_up"],
        "B_w_down": _B_in["w_down"],
    }

def reference(A_x, A_wqkv, A_wo, B_x, B_w_gate, B_w_up, B_w_down):
    def _A_ref(x, wqkv, wo):
        B, S, D = x.shape
        H = 32; Dh = D // H; W = 256
        qkv = (lambda x, *d: x.permute(*d))((x @ wqkv).reshape(B, S, 3, H, Dh), 2, 0, 3, 1, 4)
        q, k, v = qkv[0], qkv[1], qkv[2]
        scores = torch.einsum("bhqd,bhkd->bhqk", q, k) * (Dh ** -0.5)
        idx = torch.arange(S)
        mask = (idx[:, None] - idx[None, :] >= 0) & (idx[:, None] - idx[None, :] < W)
        scores = torch.where(mask[None, None], scores, -1e9)
        p = _softmax(scores, axis=-1)
        o = torch.einsum("bhqk,bhkd->bhqd", p, v)
        return (lambda x, *d: x.permute(*d))(o, 0, 2, 1, 3).reshape(B, S, D) @ wo

    def _B_ref(x, w_gate, w_up, w_down):
        g = torch.einsum("bsd,df->bsf", x, w_gate)
        u = torch.einsum("bsd,df->bsf", x, w_up)
        h = g * u
        return torch.einsum("bsf,fd->bsd", h, w_down)

    x = A_x
    h = x + _A_ref(_layernorm(x, axis=-1), A_wqkv, A_wo)
    h2 = h + _B_ref(_layernorm(h, axis=-1), B_w_gate, B_w_up, B_w_down)
    return h2
```

```asm
; @launch grid=(256,1,1) block=(256,1,1) lds=163840
.amdgcn_target "amdgcn-amd-amdhsa--gfx950"
.set CODE_BYTES, L_code_end - sequential_preLN__sliding_block__glu_gated_bilinear__prompt_kernel - 4
.text
.globl sequential_preLN__sliding_block__glu_gated_bilinear__prompt_kernel
.p2align 8
.type sequential_preLN__sliding_block__glu_gated_bilinear__prompt_kernel,@function
sequential_preLN__sliding_block__glu_gated_bilinear__prompt_kernel:
    s_cmp_ge_u32 s2, 256
    s_cbranch_scc1 L_k345_end
    s_load_dwordx4 s[4:7], s[0:1], 0
    s_load_dwordx4 s[20:23], s[0:1], 64
    s_load_dwordx4 s[12:15], s[0:1], 32
    s_load_dwordx2 s[16:17], s[0:1], 48
    s_load_dwordx2 s[8:9], s[0:1], 16
    s_memrealtime s[62:63]
    s_getpc_b64 s[52:53]
L_k1_pc:
    s_sub_u32 s52, s52, L_k1_pc - sequential_preLN__sliding_block__glu_gated_bilinear__prompt_kernel
    s_subb_u32 s53, s53, 0
    s_lshr_b32 s27, s2, 3
    s_lshl_b32 s27, s27, 11
    v_lshlrev_b32 v2, 3, v0
    v_add_u32 v2, s27, v2
    v_min_u32 v2, CODE_BYTES, v2
    global_load_dword v7, v2, s[52:53]
    v_lshrrev_b32 v2, 6, v0
    v_and_b32 v1, 63, v0
    v_readfirstlane_b32 s24, v2
    s_and_b32 s27, s2, 7
    s_lshr_b32 s28, s2, 3
    s_lshr_b32 s25, s27, 1
    s_lshl_b32 s25, s25, 2
    s_and_b32 s26, s27, 1
    s_lshl_b32 s26, s26, 3
    s_and_b32 s27, s28, 3
    s_lshr_b32 s28, s28, 2
    s_add_u32 s25, s25, s27
    s_add_u32 s26, s26, s28
    s_mov_b32 s46, 0x07060302
    s_mov_b32 s50, 0xffff0000
    v_lshlrev_b32 v6, 4, v1
    v_mov_b32 v8, 0
    v_mov_b32 v9, 1
    s_cmp_eq_u32 s26, 15
    s_cbranch_scc1 L_k1_spare
    v_lshrrev_b32 v4, 3, v1
    s_lshl_b32 s27, s25, 7
    s_lshl_b32 s28, s24, 5
    s_add_u32 s27, s27, s28
    v_add_u32 v2, s27, v4
    v_mul_u32_u24 v2, 1280, v2
    v_and_b32 v3, 7, v1
    v_lshrrev_b32 v4, 4, v1
    v_xor_b32 v3, v3, v4
    v_lshlrev_b32 v3, 4, v3
    v_xor_b32 v5, 64, v3
    v_add_u32 v12, v2, v3
    v_add_u32 v5, v2, v5
    v_add_u32 v13, 9216, v5
    v_add_u32 v14, 18432, v12
    v_add_u32 v15, 27648, v5
    s_lshl_b32 s27, s24, 4
    v_add_u32 v2, s27, v4
    v_mul_u32_u24 v2, 3840, v2
    v_bfe_u32 v3, v1, 2, 2
    v_xor_b32 v3, v3, v4
    v_lshlrev_b32 v3, 6, v3
    v_and_b32 v5, 3, v1
    v_lshl_add_u32 v3, v5, 4, v3
    s_lshl_b32 s27, s26, 8
    v_add3_u32 v16, v2, v3, s27
    v_add_u32 v17, 14336, v16
    v_add_u32 v18, 28672, v16
    v_add_u32 v19, 43008, v16
    s_lshl_b32 s31, s24, 12
    s_mov_b32 s29, 0
    s_mov_b32 s30, 0
    s_waitcnt lgkmcnt(0)
    s_mov_b32 s32, s4
    s_mov_b32 s33, s5
    s_mov_b32 s34, 0x280000
    s_mov_b32 s35, 0x00020000
    s_mov_b32 s36, s6
    s_mov_b32 s37, s7
    s_mov_b32 s38, 0x258000
    s_mov_b32 s39, 0x00020000
    s_add_u32 m0, s31, 0
    s_nop 0
    buffer_load_dwordx4 v12, s[32:35], s29 offen offset:0 lds
    buffer_load_dwordx4 v13, s[32:35], s29 offen offset:1024 lds
    buffer_load_dwordx4 v14, s[32:35], s29 offen offset:2048 lds
    buffer_load_dwordx4 v15, s[32:35], s29 offen offset:3072 lds
    s_add_u32 s29, s29, 128
    s_add_u32 m0, s31, 16384
    s_nop 0
    buffer_load_dwordx4 v16, s[36:39], s30 offen offset:0 lds
    buffer_load_dwordx4 v17, s[36:39], s30 offen offset:1024 lds
    buffer_load_dwordx4 v18, s[36:39], s30 offen offset:2048 lds
    buffer_load_dwordx4 v19, s[36:39], s30 offen offset:3072 lds
    s_add_u32 s30, s30, 245760
    v_lshrrev_b32 v3, 5, v1
    v_and_b32 v2, 31, v1
    v_mul_u32_u24 v4, 1280, v3
    v_lshl_add_u32 v20, v2, 4, v4
    v_lshl_add_u32 v21, v2, 3, v4
    s_lshl_b32 s27, s25, 4
    s_add_u32 s27, s27, s26
    s_lshl_b32 s27, s27, 2
    s_add_u32 s27, s27, s24
    s_lshl_b32 s48, s27, 4
    s_mul_i32 s49, s27, 2560
    v_lshrrev_b32 v4, 3, v1
    v_mul_u32_u24 v5, 3840, v4
    v_and_b32 v22, 7, v1
    v_lshl_add_u32 v22, v22, 3, v5
    s_mul_i32 s61, s25, 153600
    s_lshl_b32 s27, s26, 2
    s_add_u32 s27, s27, s24
    s_lshl_b32 s27, s27, 6
    s_add_u32 s61, s61, s27
    s_mov_b32 s64, s20
    s_mov_b32 s65, s21
    s_mov_b32 s66, 0x100
    s_mov_b32 s67, 0x00020000
    buffer_load_dwordx4 v[176:179], v20, s[32:35], s49 offen
    buffer_load_dwordx4 v[180:183], v20, s[32:35], s49 offen offset:512
    buffer_load_dwordx2 v[184:185], v21, s[32:35], s49 offen offset:1024
    buffer_load_dwordx2 v[188:189], v22, s[36:39], s61 offen
    s_add_u32 s61, s61, 30720
    buffer_load_dwordx2 v[190:191], v22, s[36:39], s61 offen
    s_add_u32 s61, s61, 30720
    buffer_load_dwordx2 v[192:193], v22, s[36:39], s61 offen
    s_add_u32 s61, s61, 30720
    buffer_load_dwordx2 v[194:195], v22, s[36:39], s61 offen
    s_add_u32 s61, s61, 30720
    buffer_load_dwordx2 v[196:197], v22, s[36:39], s61 offen
    s_add_u32 s61, s61, 30720
    s_add_u32 m0, s31, 32768
    s_nop 0
    buffer_load_dwordx4 v12, s[32:35], s29 offen offset:0 lds
    buffer_load_dwordx4 v13, s[32:35], s29 offen offset:1024 lds
    buffer_load_dwordx4 v14, s[32:35], s29 offen offset:2048 lds
    buffer_load_dwordx4 v15, s[32:35], s29 offen offset:3072 lds
    s_add_u32 s29, s29, 128
    s_add_u32 m0, s31, 49152
    s_nop 0
    buffer_load_dwordx4 v16, s[36:39], s30 offen offset:0 lds
    buffer_load_dwordx4 v17, s[36:39], s30 offen offset:1024 lds
    buffer_load_dwordx4 v18, s[36:39], s30 offen offset:2048 lds
    buffer_load_dwordx4 v19, s[36:39], s30 offen offset:3072 lds
    s_add_u32 s30, s30, 245760
    s_mul_i32 s18, s25, 15
    s_add_u32 s18, s18, s26
    s_cmp_ge_u32 s18, 120
    s_cselect_b32 s76, s14, s12
    s_cselect_b32 s77, s15, s13
    s_cselect_b32 s27, 120, 0
    s_cselect_b32 s58, 1, 0
    s_cselect_b32 s55, 6144, 0
    s_mov_b32 s78, 0x1e0000
    s_mov_b32 s79, 0x00020000
    s_mov_b32 s80, s16
    s_mov_b32 s81, s17
    s_mov_b32 s82, 0x1e0000
    s_mov_b32 s83, 0x00020000
    s_sub_u32 s27, s18, s27
    s_mul_i32 s28, s27, 205
    s_lshr_b32 s28, s28, 10
    s_mul_i32 s57, s28, 5
    s_sub_u32 s27, s27, s57
    s_mul_i32 s57, s27, 12288
    s_add_u32 s55, s55, s57
    s_lshl_b32 s57, s28, 8
    s_add_u32 s55, s55, s57
    s_lshl_b32 s27, s27, 2
    s_add_u32 s27, s27, s24
    s_lshl_b32 s57, s27, 2
    s_add_u32 s58, s58, s57
    s_mul_i32 s19, s27, 98304
    s_lshl_b32 s57, s28, 7
    s_add_u32 s19, s19, s57
    s_mul_i32 s27, s28, 160
    s_add_u32 s57, s27, s58
    s_lshl_b32 s57, s57, 10
    s_add_u32 s58, s57, 81920
    s_mul_i32 s56, s24, 6144
    s_add_u32 s56, s56, 131072
    v_lshrrev_b32 v4, 3, v1
    v_mul_u32_u24 v4, 3072, v4
    v_and_b32 v5, 7, v1
    v_lshl_add_u32 v25, v5, 4, v4
    v_lshrrev_b32 v4, 2, v1
    v_mul_u32_u24 v4, 1280, v4
    v_and_b32 v5, 3, v1
    v_lshl_add_u32 v26, v5, 4, v4
    v_lshlrev_b32 v24, 3, v5
    v_lshrrev_b32 v3, 5, v1
    v_bfe_u32 v2, v1, 2, 2
    v_bfe_u32 v5, v1, 4, 1
    v_lshl_add_u32 v4, v3, 2, v2
    v_lshlrev_b32 v4, 7, v4
    v_lshl_add_u32 v4, v5, 5, v4
    v_add3_u32 v23, v4, v24, s56
    v_lshl_add_u32 v4, v3, 2, v5
    v_lshl_add_u32 v4, v4, 2, v2
    v_lshlrev_b32 v4, 6, v4
    v_add3_u32 v24, v4, v24, s56
    s_mul_i32 s27, s18, 205
    s_lshr_b32 s27, s27, 10
    s_mul_i32 s59, s27, 5
    s_sub_u32 s28, s18, s59
    s_lshl_b32 s28, s28, 2
    s_add_u32 s28, s28, s24
    s_lshl_b32 s28, s28, 1
    s_mul_i32 s54, s27, 40960
    s_lshl_b32 s27, s28, 5
    s_add_u32 s54, s54, s27
    s_add_u32 s59, s59, s28
    s_add_u32 s60, s59, 1
    s_mul_i32 s27, s28, 205
    s_lshr_b32 s27, s27, 10
    s_mul_i32 s27, s27, 235
    s_add_u32 s59, s59, s27
    s_lshl_b32 s59, s59, 10
    s_add_u32 s28, s28, 1
    s_mul_i32 s27, s28, 205
    s_lshr_b32 s27, s27, 10
    s_mul_i32 s27, s27, 235
    s_add_u32 s60, s60, s27
    s_lshl_b32 s60, s60, 10
    v_lshlrev_b32 v4, 2, v1
    v_add_u32 v27, 0x26000, v4
    s_lshl_b32 s27, s24, 8
    v_add_u32 v28, s27, v27
    s_lshr_b32 s44, s24, 1
    s_and_b32 s45, s24, 1
    v_and_b32 v2, 31, v1
    v_bfe_u32 v4, v1, 1, 3
    v_xor_b32 v4, v4, v3
    v_lshlrev_b32 v4, 4, v4
    v_lshl_add_u32 v4, v2, 7, v4
    s_lshl_b32 s27, s44, 13
    v_add_u32 v4, s27, v4
    v_xor_b32 v32, 0x0, v4
    v_xor_b32 v33, 0x20, v4
    v_xor_b32 v34, 0x40, v4
    v_xor_b32 v35, 0x60, v4
    v_xor_b32 v36, 0x10000, v4
    v_xor_b32 v37, 0x10020, v4
    v_xor_b32 v38, 0x10040, v4
    v_xor_b32 v39, 0x10060, v4
    v_bfe_u32 v4, v1, 2, 2
    v_lshl_add_u32 v5, v3, 3, v4
    v_lshlrev_b32 v5, 8, v5
    s_lshl_b32 s27, s45, 1
    v_xor_b32 v4, s27, v4
    v_lshl_add_u32 v5, v4, 6, v5
    v_bfe_u32 v4, v1, 4, 1
    v_lshl_add_u32 v5, v4, 5, v5
    v_and_b32 v4, 3, v1
    v_lshl_add_u32 v5, v4, 3, v5
    v_xor_b32 v40, 0x4000, v5
    v_xor_b32 v41, 0x4040, v5
    v_xor_b32 v42, 0x14000, v5
    v_xor_b32 v43, 0x14040, v5
    s_lshl_b32 s27, s26, 1
    s_add_u32 s27, s27, s45
    s_lshl_b32 s27, s27, 12
    v_add_u32 v44, s27, v6
    v_lshlrev_b32 v4, 2, v2
    s_lshl_b32 s27, s45, 8
    s_add_u32 s27, s27, 156672
    v_add_u32 v45, s27, v4
    s_lshl_b32 s27, s44, 8
    s_add_u32 s27, s27, 157184
    v_add_u32 v46, s27, v4
    s_lshl_b32 s27, s24, 7
    s_add_u32 s27, s27, 156672
    v_add_u32 v49, s27, v4
    v_lshlrev_b32 v4, 3, v2
    s_lshl_b32 s27, s26, 14
    s_lshl_b32 s28, s24, 8
    s_add_u32 s27, s27, s28
    s_add_u32 s27, s27, 16384
    v_lshl_add_u32 v5, v3, 10, v4
    v_add_u32 v47, s27, v5
    s_lshl_b32 s61, s25, 10
    s_add_u32 s49, s27, s61
    s_add_u32 s27, s61, s28
    v_add_u32 v48, s27, v4
    s_mov_b32 s47, 1.0
    s_cmp_lt_u32 s26, 5
    s_cselect_b32 s47, 0x3ea52b5c, s47
    s_mov_b32 s88, 0x01000100
    s_add_u32 s68, s22, 0x1c40000
    s_addc_u32 s69, s23, 0
    s_mov_b32 s70, 0x40000
    s_mov_b32 s71, 0x00020000
    s_add_u32 s72, s22, 0x1c00000
    s_addc_u32 s73, s23, 0
    s_mov_b32 s74, 0x20000
    s_mov_b32 s75, 0x00020000
    s_mov_b32 s40, s22
    s_mov_b32 s41, s23
    s_mov_b32 s42, 0x780000
    s_mov_b32 s43, 0x00020000
    v_mov_b32 v54, 0
    v_mov_b32 v62, 0
    v_mov_b32 v55, 0
    v_mov_b32 v63, 0
    v_mov_b32 v58, 0
    v_mov_b32 v66, 0
    v_mov_b32 v59, 0
    v_mov_b32 v67, 0
    s_waitcnt vmcnt(16) lgkmcnt(0)
    s_barrier
    ds_read_b128 v[76:79], v32 offset:0
    ds_read_b64_tr_b16 v[92:93], v40 offset:0
    ds_read_b64_tr_b16 v[94:95], v40 offset:1024
    ds_read_b128 v[80:83], v32 offset:4096
    ds_read_b64_tr_b16 v[96:97], v41 offset:0
    ds_read_b64_tr_b16 v[98:99], v41 offset:1024
    s_waitcnt lgkmcnt(0)
    v_mfma_f32_32x32x16_bf16 v[108:123], v[92:95], v[76:79], 0
    ds_read_b128 v[84:87], v33 offset:0
    ds_read_b64_tr_b16 v[100:101], v40 offset:4096
    ds_read_b64_tr_b16 v[102:103], v40 offset:5120
    v_mfma_f32_32x32x16_bf16 v[124:139], v[92:95], v[80:83], 0
    ds_read_b128 v[88:91], v33 offset:4096
    ds_read_b64_tr_b16 v[104:105], v41 offset:4096
    ds_read_b64_tr_b16 v[106:107], v41 offset:5120
    v_mfma_f32_32x32x16_bf16 v[140:155], v[96:99], v[76:79], 0
    s_add_u32 m0, s31, 65536
    s_nop 0
    buffer_load_dwordx4 v12, s[32:35], s29 offen offset:0 lds
    buffer_load_dwordx4 v13, s[32:35], s29 offen offset:1024 lds
    v_mfma_f32_32x32x16_bf16 v[156:171], v[96:99], v[80:83], 0
    buffer_load_dwordx4 v14, s[32:35], s29 offen offset:2048 lds
    buffer_load_dwordx4 v15, s[32:35], s29 offen offset:3072 lds
    s_add_u32 s29, s29, 128
    s_waitcnt lgkmcnt(0)
    v_mfma_f32_32x32x16_bf16 v[108:123], v[100:103], v[84:87], v[108:123]
    ds_read_b128 v[76:79], v34 offset:0
    ds_read_b64_tr_b16 v[92:93], v40 offset:8192
    ds_read_b64_tr_b16 v[94:95], v40 offset:9216
    v_mfma_f32_32x32x16_bf16 v[124:139], v[100:103], v[88:91], v[124:139]
    ds_read_b128 v[80:83], v34 offset:4096
    ds_read_b64_tr_b16 v[96:97], v41 offset:8192
    ds_read_b64_tr_b16 v[98:99], v41 offset:9216
    v_mfma_f32_32x32x16_bf16 v[140:155], v[104:107], v[84:87], v[140:155]
    s_add_u32 m0, s31, 81920
    s_nop 0
    buffer_load_dwordx4 v16, s[36:39], s30 offen offset:0 lds
    buffer_load_dwordx4 v17, s[36:39], s30 offen offset:1024 lds
    v_mfma_f32_32x32x16_bf16 v[156:171], v[104:107], v[88:91], v[156:171]
    buffer_load_dwordx4 v18, s[36:39], s30 offen offset:2048 lds
    buffer_load_dwordx4 v19, s[36:39], s30 offen offset:3072 lds
    s_add_u32 s30, s30, 245760
    s_waitcnt lgkmcnt(0)
    v_mfma_f32_32x32x16_bf16 v[108:123], v[92:95], v[76:79], v[108:123]
    ds_read_b128 v[84:87], v35 offset:0
    ds_read_b64_tr_b16 v[100:101], v40 offset:12288
    ds_read_b64_tr_b16 v[102:103], v40 offset:13312
    ds_read_b128 v[88:91], v35 offset:4096
    ds_read_b64_tr_b16 v[104:105], v41 offset:12288
    ds_read_b64_tr_b16 v[106:107], v41 offset:13312
    s_add_u32 m0, s31, 98304
    v_mfma_f32_32x32x16_bf16 v[124:139], v[92:95], v[80:83], v[124:139]
    buffer_load_dwordx4 v12, s[32:35], s29 offen offset:0 lds
    buffer_load_dwordx4 v13, s[32:35], s29 offen offset:1024 lds
    buffer_load_dwordx4 v14, s[32:35], s29 offen offset:2048 lds
    buffer_load_dwordx4 v15, s[32:35], s29 offen offset:3072 lds
    s_add_u32 s29, s29, 128
    s_waitcnt vmcnt(20)
    v_and_b32 v208, s50, v176
    v_mfma_f32_32x32x16_bf16 v[140:155], v[96:99], v[76:79], v[140:155]
    v_lshlrev_b32 v209, 16, v176
    v_mov_b32 v200, v208
    v_mov_b32 v201, v209
    v_mul_f32 v202, v208, v208
    v_mul_f32 v203, v209, v209
    v_and_b32 v210, s50, v177
    v_lshlrev_b32 v211, 16, v177
    v_mfma_f32_32x32x16_bf16 v[156:171], v[96:99], v[80:83], v[156:171]
    v_add_f32 v200, v200, v210
    v_fmac_f32 v202, v210, v210
    v_add_f32 v201, v201, v211
    v_fmac_f32 v203, v211, v211
    v_and_b32 v212, s50, v178
    s_waitcnt vmcnt(12) lgkmcnt(0)
    s_barrier
    v_mfma_f32_32x32x16_bf16 v[108:123], v[100:103], v[84:87], v[108:123]
    ds_read_b128 v[76:79], v32 offset:32768
    ds_read_b64_tr_b16 v[92:93], v40 offset:32768
    ds_read_b64_tr_b16 v[94:95], v40 offset:33792
    ds_read_b128 v[80:83], v32 offset:36864
    ds_read_b64_tr_b16 v[96:97], v41 offset:32768
    ds_read_b64_tr_b16 v[98:99], v41 offset:33792
    s_add_u32 m0, s31, 114688
    v_mfma_f32_32x32x16_bf16 v[124:139], v[100:103], v[88:91], v[124:139]
    buffer_load_dwordx4 v16, s[36:39], s30 offen offset:0 lds
    buffer_load_dwordx4 v17, s[36:39], s30 offen offset:1024 lds
    buffer_load_dwordx4 v18, s[36:39], s30 offen offset:2048 lds
    buffer_load_dwordx4 v19, s[36:39], s30 offen offset:3072 lds
    s_add_u32 s30, s30, 245760
    v_lshlrev_b32 v213, 16, v178
    v_add_f32 v200, v200, v212
    v_mfma_f32_32x32x16_bf16 v[140:155], v[104:107], v[84:87], v[140:155]
    v_fmac_f32 v202, v212, v212
    v_add_f32 v201, v201, v213
    v_fmac_f32 v203, v213, v213
    v_and_b32 v214, s50, v179
    v_lshlrev_b32 v215, 16, v179
    v_add_f32 v200, v200, v214
    v_fmac_f32 v202, v214, v214
    v_mfma_f32_32x32x16_bf16 v[156:171], v[104:107], v[88:91], v[156:171]
    v_add_f32 v201, v201, v215
    v_fmac_f32 v203, v215, v215
    v_and_b32 v208, s50, v180
    v_lshlrev_b32 v209, 16, v180
    v_add_f32 v200, v200, v208
    s_waitcnt lgkmcnt(0)
    v_mfma_f32_32x32x16_bf16 v[108:123], v[92:95], v[76:79], v[108:123]
    ds_read_b128 v[84:87], v33 offset:32768
    ds_read_b64_tr_b16 v[100:101], v40 offset:36864
    ds_read_b64_tr_b16 v[102:103], v40 offset:37888
    ds_read_b128 v[88:91], v33 offset:36864
    ds_read_b64_tr_b16 v[104:105], v41 offset:36864
    ds_read_b64_tr_b16 v[106:107], v41 offset:37888
    v_mfma_f32_32x32x16_bf16 v[124:139], v[92:95], v[80:83], v[124:139]
    s_add_u32 m0, s31, 0
    s_nop 0
    buffer_load_dwordx4 v12, s[32:35], s29 offen offset:0 lds
    buffer_load_dwordx4 v13, s[32:35], s29 offen offset:1024 lds
    v_fmac_f32 v202, v208, v208
    v_add_f32 v201, v201, v209
    v_fmac_f32 v203, v209, v209
    v_mfma_f32_32x32x16_bf16 v[140:155], v[96:99], v[76:79], v[140:155]
    v_and_b32 v210, s50, v181
    v_lshlrev_b32 v211, 16, v181
    v_add_f32 v200, v200, v210
    v_fmac_f32 v202, v210, v210
    v_add_f32 v201, v201, v211
    v_fmac_f32 v203, v211, v211
    v_mfma_f32_32x32x16_bf16 v[156:171], v[96:99], v[80:83], v[156:171]
    v_and_b32 v212, s50, v182
    v_lshlrev_b32 v213, 16, v182
    v_add_f32 v200, v200, v212
    v_fmac_f32 v202, v212, v212
    v_add_f32 v201, v201, v213
    s_waitcnt lgkmcnt(0)
    v_mfma_f32_32x32x16_bf16 v[108:123], v[100:103], v[84:87], v[108:123]
    ds_read_b128 v[76:79], v34 offset:32768
    ds_read_b64_tr_b16 v[92:93], v40 offset:40960
    ds_read_b64_tr_b16 v[94:95], v40 offset:41984
    ds_read_b128 v[80:83], v34 offset:36864
    ds_read_b64_tr_b16 v[96:97], v41 offset:40960
    ds_read_b64_tr_b16 v[98:99], v41 offset:41984
    v_mfma_f32_32x32x16_bf16 v[124:139], v[100:103], v[88:91], v[124:139]
    buffer_load_dwordx4 v14, s[32:35], s29 offen offset:2048 lds
    buffer_load_dwordx4 v15, s[32:35], s29 offen offset:3072 lds
    s_add_u32 s29, s29, 128
    v_fmac_f32 v203, v213, v213
    v_and_b32 v214, s50, v183
    v_lshlrev_b32 v215, 16, v183
    v_mfma_f32_32x32x16_bf16 v[140:155], v[104:107], v[84:87], v[140:155]
    v_add_f32 v200, v200, v214
    v_fmac_f32 v202, v214, v214
    v_add_f32 v201, v201, v215
    v_fmac_f32 v203, v215, v215
    v_and_b32 v208, s50, v184
    v_lshlrev_b32 v209, 16, v184
    v_mfma_f32_32x32x16_bf16 v[156:171], v[104:107], v[88:91], v[156:171]
    v_add_f32 v200, v200, v208
    v_fmac_f32 v202, v208, v208
    v_add_f32 v201, v201, v209
    v_fmac_f32 v203, v209, v209
    v_and_b32 v210, s50, v185
    s_waitcnt lgkmcnt(0)
    v_mfma_f32_32x32x16_bf16 v[108:123], v[92:95], v[76:79], v[108:123]
    ds_read_b128 v[84:87], v35 offset:32768
    ds_read_b64_tr_b16 v[100:101], v40 offset:45056
    ds_read_b64_tr_b16 v[102:103], v40 offset:46080
    ds_read_b128 v[88:91], v35 offset:36864
    ds_read_b64_tr_b16 v[104:105], v41 offset:45056
    ds_read_b64_tr_b16 v[106:107], v41 offset:46080
    v_mfma_f32_32x32x16_bf16 v[124:139], v[92:95], v[80:83], v[124:139]
    s_add_u32 m0, s31, 16384
    s_nop 0
    buffer_load_dwordx4 v16, s[36:39], s30 offen offset:0 lds
    buffer_load_dwordx4 v17, s[36:39], s30 offen offset:1024 lds
    v_lshlrev_b32 v211, 16, v185
    v_add_f32 v200, v200, v210
    v_fmac_f32 v202, v210, v210
    v_mfma_f32_32x32x16_bf16 v[140:155], v[96:99], v[76:79], v[140:155]
    v_add_f32 v201, v201, v211
    v_fmac_f32 v203, v211, v211
    v_add_f32 v200, v200, v201
    v_add_f32 v202, v202, v203
    s_nop 0
    v_add_f32_dpp v200, v200, v200 row_ror:8 row_mask:0xf bank_mask:0xf
    v_add_f32_dpp v202, v202, v202 row_ror:8 row_mask:0xf bank_mask:0xf
    v_mfma_f32_32x32x16_bf16 v[156:171], v[96:99], v[80:83], v[156:171]
    v_add_f32_dpp v200, v200, v200 row_ror:4 row_mask:0xf bank_mask:0xf
    v_add_f32_dpp v202, v202, v202 row_ror:4 row_mask:0xf bank_mask:0xf
    s_nop 0
    v_add_f32_dpp v200, v200, v200 row_ror:2 row_mask:0xf bank_mask:0xf
    v_add_f32_dpp v202, v202, v202 row_ror:2 row_mask:0xf bank_mask:0xf
    s_nop 0
    v_add_f32_dpp v200, v200, v200 row_ror:1 row_mask:0xf bank_mask:0xf
    s_waitcnt vmcnt(14) lgkmcnt(0)
    s_barrier
    v_mfma_f32_32x32x16_bf16 v[108:123], v[100:103], v[84:87], v[108:123]
    ds_read_b128 v[76:79], v36 offset:0
    ds_read_b64_tr_b16 v[92:93], v42 offset:0
    ds_read_b64_tr_b16 v[94:95], v42 offset:1024
    ds_read_b128 v[80:83], v36 offset:4096
    ds_read_b64_tr_b16 v[96:97], v43 offset:0
    ds_read_b64_tr_b16 v[98:99], v43 offset:1024
    v_mfma_f32_32x32x16_bf16 v[124:139], v[100:103], v[88:91], v[124:139]
    buffer_load_dwordx4 v18, s[36:39], s30 offen offset:2048 lds
    buffer_load_dwordx4 v19, s[36:39], s30 offen offset:3072 lds
    s_add_u32 s30, s30, 245760
    v_add_f32_dpp v202, v202, v202 row_ror:1 row_mask:0xf bank_mask:0xf
    v_mov_b32 v201, v200
    v_mov_b32 v203, v202
    v_mfma_f32_32x32x16_bf16 v[140:155], v[104:107], v[84:87], v[140:155]
    v_permlane16_swap_b32 v200, v201
    v_permlane16_swap_b32 v202, v203
    v_add_f32 v200, v200, v201
    v_add_f32 v202, v202, v203
    v_mul_f32 v200, 0x3acccccd, v200
    v_mul_f32 v202, 0x3acccccd, v202
    v_mfma_f32_32x32x16_bf16 v[156:171], v[104:107], v[88:91], v[156:171]
    v_fma_f32 v202, -v200, v200, v202
    v_max_f32 v202, 0, v202
    v_cvt_pk_bf16_f32 v208, v200, v200
    v_lshlrev_b32 v208, 16, v208
    v_xor_b32 v201, 0x80000000, v208
    s_waitcnt lgkmcnt(0)
    v_mfma_f32_32x32x16_bf16 v[108:123], v[92:95], v[76:79], v[108:123]
    ds_read_b128 v[84:87], v37 offset:0
    ds_read_b64_tr_b16 v[100:101], v42 offset:4096
    ds_read_b64_tr_b16 v[102:103], v42 offset:5120
    ds_read_b128 v[88:91], v37 offset:4096
    ds_read_b64_tr_b16 v[104:105], v43 offset:4096
    ds_read_b64_tr_b16 v[106:107], v43 offset:5120
    v_mfma_f32_32x32x16_bf16 v[124:139], v[92:95], v[80:83], v[124:139]
    s_add_u32 m0, s31, 32768
    s_nop 0
    buffer_load_dwordx4 v12, s[32:35], s29 offen offset:0 lds
    buffer_load_dwordx4 v13, s[32:35], s29 offen offset:1024 lds
    buffer_load_dword v10, v8, s[64:67], 0 offen sc1
    v_cvt_pk_bf16_f32 v202, v202, v202
    v_lshlrev_b32 v202, 16, v202
    v_mfma_f32_32x32x16_bf16 v[140:155], v[96:99], v[76:79], v[140:155]
    v_add_f32 v202, 0x3727c5ac, v202
    v_cvt_pk_bf16_f32 v202, v202, v202
    v_lshlrev_b32 v202, 16, v202
    v_sqrt_f32 v202, v202
    s_nop 0
    v_cvt_pk_bf16_f32 v202, v202, v202
    v_lshlrev_b32 v202, 16, v202
    v_mfma_f32_32x32x16_bf16 v[156:171], v[96:99], v[80:83], v[156:171]
    v_perm_b32 v204, v202, v201, s46
    v_lshrrev_b32 v20, 5, v1
    v_lshlrev_b32 v20, 3, v20
    v_lshl_add_u32 v20, v1, 27, v20
    v_lshlrev_b32 v176, 16, v188
    v_and_b32 v177, s50, v188
    s_waitcnt lgkmcnt(0)
    v_mfma_f32_32x32x16_bf16 v[108:123], v[100:103], v[84:87], v[108:123]
    ds_read_b128 v[76:79], v38 offset:0
    ds_read_b64_tr_b16 v[92:93], v42 offset:8192
    ds_read_b64_tr_b16 v[94:95], v42 offset:9216
    ds_read_b128 v[80:83], v38 offset:4096
    ds_read_b64_tr_b16 v[96:97], v43 offset:8192
    ds_read_b64_tr_b16 v[98:99], v43 offset:9216
    v_mfma_f32_32x32x16_bf16 v[124:139], v[100:103], v[88:91], v[124:139]
    buffer_load_dwordx4 v14, s[32:35], s29 offen offset:2048 lds
    buffer_load_dwordx4 v15, s[32:35], s29 offen offset:3072 lds
    s_add_u32 s29, s29, 128
    v_lshlrev_b32 v178, 16, v189
    v_and_b32 v179, s50, v189
    v_lshlrev_b32 v208, 16, v190
    v_mfma_f32_32x32x16_bf16 v[140:155], v[104:107], v[84:87], v[140:155]
    v_and_b32 v209, s50, v190
    v_add_f32 v176, v176, v208
    v_add_f32 v177, v177, v209
    v_lshlrev_b32 v210, 16, v191
    v_and_b32 v211, s50, v191
    v_add_f32 v178, v178, v210
    v_mfma_f32_32x32x16_bf16 v[156:171], v[104:107], v[88:91], v[156:171]
    v_add_f32 v179, v179, v211
    v_lshlrev_b32 v208, 16, v192
    v_and_b32 v209, s50, v192
    v_add_f32 v176, v176, v208
    v_add_f32 v177, v177, v209
    s_waitcnt lgkmcnt(0)
    v_mfma_f32_32x32x16_bf16 v[108:123], v[92:95], v[76:79], v[108:123]
    ds_read_b128 v[84:87], v39 offset:0
    ds_read_b64_tr_b16 v[100:101], v42 offset:12288
    ds_read_b64_tr_b16 v[102:103], v42 offset:13312
    ds_read_b128 v[88:91], v39 offset:4096
    ds_read_b64_tr_b16 v[104:105], v43 offset:12288
    ds_read_b64_tr_b16 v[106:107], v43 offset:13312
    v_mfma_f32_32x32x16_bf16 v[124:139], v[92:95], v[80:83], v[124:139]
    s_add_u32 m0, s31, 49152
    s_nop 0
    buffer_load_dwordx4 v16, s[36:39], s30 offen offset:0 lds
    buffer_load_dwordx4 v17, s[36:39], s30 offen offset:1024 lds
    v_lshlrev_b32 v210, 16, v193
    v_and_b32 v211, s50, v193
    v_add_f32 v178, v178, v210
    v_mfma_f32_32x32x16_bf16 v[140:155], v[96:99], v[76:79], v[140:155]
    v_add_f32 v179, v179, v211
    v_lshlrev_b32 v208, 16, v194
    v_and_b32 v209, s50, v194
    v_add_f32 v176, v176, v208
    v_add_f32 v177, v177, v209
    v_lshlrev_b32 v210, 16, v195
    v_mfma_f32_32x32x16_bf16 v[156:171], v[96:99], v[80:83], v[156:171]
    v_and_b32 v211, s50, v195
    v_add_f32 v178, v178, v210
    v_add_f32 v179, v179, v211
    v_lshlrev_b32 v208, 16, v196
    v_and_b32 v209, s50, v196
    s_waitcnt vmcnt(15) lgkmcnt(0)
    s_barrier
    v_mfma_f32_32x32x16_bf16 v[108:123], v[100:103], v[84:87], v[108:123]
    ds_read_b128 v[76:79], v36 offset:32768
    ds_read_b64_tr_b16 v[92:93], v42 offset:32768
    ds_read_b64_tr_b16 v[94:95], v42 offset:33792
    ds_read_b128 v[80:83], v36 offset:36864
    ds_read_b64_tr_b16 v[96:97], v43 offset:32768
    ds_read_b64_tr_b16 v[98:99], v43 offset:33792
    v_mfma_f32_32x32x16_bf16 v[124:139], v[100:103], v[88:91], v[124:139]
    buffer_load_dwordx4 v18, s[36:39], s30 offen offset:2048 lds
    buffer_load_dwordx4 v19, s[36:39], s30 offen offset:3072 lds
    s_add_u32 s30, s30, 245760
    v_add_f32 v176, v176, v208
    v_add_f32 v177, v177, v209
    v_lshlrev_b32 v210, 16, v197
    v_mfma_f32_32x32x16_bf16 v[140:155], v[104:107], v[84:87], v[140:155]
    v_and_b32 v211, s50, v197
    v_add_f32 v178, v178, v210
    v_add_f32 v179, v179, v211
    v_and_b32 v22, 7, v1
    v_lshrrev_b32 v208, 4, v1
    v_permlane32_swap_b32 v176, v178
    v_mfma_f32_32x32x16_bf16 v[156:171], v[104:107], v[88:91], v[156:171]
    v_permlane32_swap_b32 v177, v179
    v_add_f32 v176, v176, v178
    v_add_f32 v177, v177, v179
    v_lshl_add_u32 v22, v22, 2, v208
    v_lshlrev_b32 v22, 3, v22
    s_waitcnt lgkmcnt(0)
    v_mfma_f32_32x32x16_bf16 v[108:123], v[92:95], v[76:79], v[108:123]
    ds_read_b128 v[84:87], v37 offset:32768
    ds_read_b64_tr_b16 v[100:101], v42 offset:36864
    ds_read_b64_tr_b16 v[102:103], v42 offset:37888
    ds_read_b128 v[88:91], v37 offset:36864
    v_mfma_f32_32x32x16_bf16 v[124:139], v[92:95], v[80:83], v[124:139]
    ds_read_b64_tr_b16 v[104:105], v43 offset:36864
    ds_read_b64_tr_b16 v[106:107], v43 offset:37888
    s_add_u32 m0, s31, 65536
    s_nop 0
    buffer_load_dwordx4 v12, s[32:35], s29 offen offset:0 lds
    v_mfma_f32_32x32x16_bf16 v[140:155], v[96:99], v[76:79], v[140:155]
    buffer_load_dwordx4 v13, s[32:35], s29 offen offset:1024 lds
    v_permlane16_swap_b32 v176, v177
    v_add_f32 v176, v176, v177
    v_bfe_u32 v208, v1, 3, 1
    v_mfma_f32_32x32x16_bf16 v[156:171], v[96:99], v[80:83], v[156:171]
    v_lshl_add_u32 v22, v208, 30, v22
    v_add_f32_dpp v206, v176, v176 row_ror:8 row_mask:0xf bank_mask:0xf
    s_waitcnt vmcnt(8)
    v_readfirstlane_b32 s51, v10
    s_nop 1
    s_cmp_eq_u32 s51, 0
    s_cbranch_scc1 L_k1_eps_m
L_k1_epok_m:
    v_mov_b32 v205, s51
    v_mov_b32 v207, s51
    buffer_store_dwordx2 v[204:205], v20, s[68:71], s48 offen sc1
    buffer_store_dwordx2 v[206:207], v22, s[68:71], s49 offen sc1
    s_lshl_b32 s27, s25, 2
    s_lshl_b32 s28, s44, 1
    s_add_u32 s27, s27, s28
    s_mul_i32 s48, s27, 122880
    s_add_u32 s49, s48, 122880
    s_movk_i32 s61, 0x1000
    s_movk_i32 s89, 0x2000
    s_movk_i32 s90, 0x3000
    s_movk_i32 s98, 64
    s_waitcnt lgkmcnt(0)
    v_mfma_f32_32x32x16_bf16 v[108:123], v[100:103], v[84:87], v[108:123]
    ds_read_b128 v[76:79], v38 offset:32768
    ds_read_b64_tr_b16 v[92:93], v42 offset:40960
    ds_read_b64_tr_b16 v[94:95], v42 offset:41984
    ds_read_b128 v[80:83], v38 offset:36864
    v_mfma_f32_32x32x16_bf16 v[124:139], v[100:103], v[88:91], v[124:139]
    ds_read_b64_tr_b16 v[96:97], v43 offset:40960
    ds_read_b64_tr_b16 v[98:99], v43 offset:41984
    buffer_load_dwordx4 v14, s[32:35], s29 offen offset:2048 lds
    buffer_load_dwordx4 v15, s[32:35], s29 offen offset:3072 lds
    v_mfma_f32_32x32x16_bf16 v[140:155], v[104:107], v[84:87], v[140:155]
    s_add_u32 s29, s29, 128
    s_add_u32 m0, s56, 0
    s_nop 0
    buffer_load_dwordx4 v25, s[76:79], s19 offen lds
    s_add_u32 s19, s19, 24576
    v_mfma_f32_32x32x16_bf16 v[156:171], v[104:107], v[88:91], v[156:171]
    s_add_u32 m0, s56, 1024
    s_nop 0
    buffer_load_dwordx4 v25, s[76:79], s19 offen lds
    s_add_u32 s19, s19, 24576
    s_waitcnt lgkmcnt(0)
    v_mfma_f32_32x32x16_bf16 v[108:123], v[92:95], v[76:79], v[108:123]
    ds_read_b128 v[84:87], v39 offset:32768
    ds_read_b64_tr_b16 v[100:101], v42 offset:45056
    ds_read_b64_tr_b16 v[102:103], v42 offset:46080
    v_mfma_f32_32x32x16_bf16 v[124:139], v[92:95], v[80:83], v[124:139]
    ds_read_b128 v[88:91], v39 offset:36864
    ds_read_b64_tr_b16 v[104:105], v43 offset:45056
    ds_read_b64_tr_b16 v[106:107], v43 offset:46080
    v_mfma_f32_32x32x16_bf16 v[140:155], v[96:99], v[76:79], v[140:155]
    s_add_u32 m0, s31, 81920
    s_nop 0
    buffer_load_dwordx4 v16, s[36:39], s30 offen offset:0 lds
    buffer_load_dwordx4 v17, s[36:39], s30 offen offset:1024 lds
    v_mfma_f32_32x32x16_bf16 v[156:171], v[96:99], v[80:83], v[156:171]
    s_waitcnt vmcnt(19) lgkmcnt(0)
    s_barrier
    v_mfma_f32_32x32x16_bf16 v[108:123], v[100:103], v[84:87], v[108:123]
    ds_read_b128 v[76:79], v32 offset:0
    ds_read_b64_tr_b16 v[92:93], v40 offset:0
    ds_read_b64_tr_b16 v[94:95], v40 offset:1024
    ds_read_b128 v[80:83], v32 offset:4096
    v_mfma_f32_32x32x16_bf16 v[124:139], v[100:103], v[88:91], v[124:139]
    ds_read_b64_tr_b16 v[96:97], v41 offset:0
    ds_read_b64_tr_b16 v[98:99], v41 offset:1024
    buffer_load_dwordx4 v18, s[36:39], s30 offen offset:2048 lds
    buffer_load_dwordx4 v19, s[36:39], s30 offen offset:3072 lds
    v_mfma_f32_32x32x16_bf16 v[140:155], v[104:107], v[84:87], v[140:155]
    s_add_u32 s30, s30, 245760
    s_add_u32 m0, s56, 2048
    s_nop 0
    buffer_load_dwordx4 v25, s[76:79], s19 offen lds
    s_add_u32 s19, s19, 24576
    v_mfma_f32_32x32x16_bf16 v[156:171], v[104:107], v[88:91], v[156:171]
    s_add_u32 m0, s56, 3072
    s_nop 0
    buffer_load_dwordx4 v25, s[76:79], s19 offen lds
    s_add_u32 s19, s19, 24576
    s_waitcnt lgkmcnt(0)
    v_mfma_f32_32x32x16_bf16 v[108:123], v[92:95], v[76:79], v[108:123]
    ds_read_b128 v[84:87], v33 offset:0
    ds_read_b64_tr_b16 v[100:101], v40 offset:4096
    ds_read_b64_tr_b16 v[102:103], v40 offset:5120
    v_mfma_f32_32x32x16_bf16 v[124:139], v[92:95], v[80:83], v[124:139]
    ds_read_b128 v[88:91], v33 offset:4096
    ds_read_b64_tr_b16 v[104:105], v41 offset:4096
    ds_read_b64_tr_b16 v[106:107], v41 offset:5120
    v_mfma_f32_32x32x16_bf16 v[140:155], v[96:99], v[76:79], v[140:155]
    s_add_u32 m0, s31, 98304
    s_nop 0
    buffer_load_dwordx4 v12, s[32:35], s29 offen offset:0 lds
    buffer_load_dwordx4 v13, s[32:35], s29 offen offset:1024 lds
    v_mfma_f32_32x32x16_bf16 v[156:171], v[96:99], v[80:83], v[156:171]
    s_waitcnt lgkmcnt(0)
    v_mfma_f32_32x32x16_bf16 v[108:123], v[100:103], v[84:87], v[108:123]
    ds_read_b128 v[76:79], v34 offset:0
    ds_read_b64_tr_b16 v[92:93], v40 offset:8192
    ds_read_b64_tr_b16 v[94:95], v40 offset:9216
    ds_read_b128 v[80:83], v34 offset:4096
    v_mfma_f32_32x32x16_bf16 v[124:139], v[100:103], v[88:91], v[124:139]
    ds_read_b64_tr_b16 v[96:97], v41 offset:8192
    ds_read_b64_tr_b16 v[98:99], v41 offset:9216
    buffer_load_dwordx4 v14, s[32:35], s29 offen offset:2048 lds
    buffer_load_dwordx4 v15, s[32:35], s29 offen offset:3072 lds
    v_mfma_f32_32x32x16_bf16 v[140:155], v[104:107], v[84:87], v[140:155]
    s_add_u32 s29, s29, 128
    s_add_u32 m0, s56, 4096
    s_nop 0
    buffer_load_dwordx4 v26, s[80:83], s54 offen lds
    s_add_u32 s54, s54, 20480
    v_mfma_f32_32x32x16_bf16 v[156:171], v[104:107], v[88:91], v[156:171]
    s_add_u32 m0, s56, 5120
    s_nop 0
    buffer_load_dwordx4 v26, s[80:83], s54 offen lds
    s_add_u32 s54, s54, 20480
    s_waitcnt lgkmcnt(0)
    v_mfma_f32_32x32x16_bf16 v[108:123], v[92:95], v[76:79], v[108:123]
    ds_read_b128 v[84:87], v35 offset:0
    ds_read_b64_tr_b16 v[100:101], v40 offset:12288
    ds_read_b64_tr_b16 v[102:103], v40 offset:13312
    v_mfma_f32_32x32x16_bf16 v[124:139], v[92:95], v[80:83], v[124:139]
    ds_read_b128 v[88:91], v35 offset:4096
    ds_read_b64_tr_b16 v[104:105], v41 offset:12288
    ds_read_b64_tr_b16 v[106:107], v41 offset:13312
    v_mfma_f32_32x32x16_bf16 v[140:155], v[96:99], v[76:79], v[140:155]
    s_add_u32 m0, s31, 114688
    s_nop 0
    buffer_load_dwordx4 v16, s[36:39], s30 offen offset:0 lds
    buffer_load_dwordx4 v17, s[36:39], s30 offen offset:1024 lds
    v_mfma_f32_32x32x16_bf16 v[156:171], v[96:99], v[80:83], v[156:171]
    s_waitcnt vmcnt(22) lgkmcnt(0)
    s_barrier
    v_mfma_f32_32x32x16_bf16 v[108:123], v[100:103], v[84:87], v[108:123]
    ds_read_b128 v[76:79], v32 offset:32768
    ds_read_b64_tr_b16 v[92:93], v40 offset:32768
    ds_read_b64_tr_b16 v[94:95], v40 offset:33792
    v_mfma_f32_32x32x16_bf16 v[124:139], v[100:103], v[88:91], v[124:139]
    ds_read_b128 v[80:83], v32 offset:36864
    ds_read_b64_tr_b16 v[96:97], v41 offset:32768
    ds_read_b64_tr_b16 v[98:99], v41 offset:33792
    v_mfma_f32_32x32x16_bf16 v[140:155], v[104:107], v[84:87], v[140:155]
    buffer_load_dwordx4 v18, s[36:39], s30 offen offset:2048 lds
    buffer_load_dwordx4 v19, s[36:39], s30 offen offset:3072 lds
    s_add_u32 s30, s30, 245760
    v_mfma_f32_32x32x16_bf16 v[156:171], v[104:107], v[88:91], v[156:171]
    s_waitcnt lgkmcnt(0)
    v_mfma_f32_32x32x16_bf16 v[108:123], v[92:95], v[76:79], v[108:123]
    ds_read_b128 v[84:87], v33 offset:32768
    ds_read_b64_tr_b16 v[100:101], v40 offset:36864
    ds_read_b64_tr_b16 v[102:103], v40 offset:37888
    v_mfma_f32_32x32x16_bf16 v[124:139], v[92:95], v[80:83], v[124:139]
    ds_read_b128 v[88:91], v33 offset:36864
    ds_read_b64_tr_b16 v[104:105], v41 offset:36864
    ds_read_b64_tr_b16 v[106:107], v41 offset:37888
    v_mfma_f32_32x32x16_bf16 v[140:155], v[96:99], v[76:79], v[140:155]
    s_add_u32 m0, s31, 0
    s_nop 0
    buffer_load_dwordx4 v12, s[32:35], s29 offen offset:0 lds
    buffer_load_dwordx4 v13, s[32:35], s29 offen offset:1024 lds
    v_mfma_f32_32x32x16_bf16 v[156:171], v[96:99], v[80:83], v[156:171]
    s_waitcnt lgkmcnt(0)
    v_mfma_f32_32x32x16_bf16 v[108:123], v[100:103], v[84:87], v[108:123]
    ds_read_b128 v[76:79], v34 offset:32768
    ds_read_b64_tr_b16 v[92:93], v40 offset:40960
    ds_read_b64_tr_b16 v[94:95], v40 offset:41984
    v_mfma_f32_32x32x16_bf16 v[124:139], v[100:103], v[88:91], v[124:139]
    ds_read_b128 v[80:83], v34 offset:36864
    ds_read_b64_tr_b16 v[96:97], v41 offset:40960
    ds_read_b64_tr_b16 v[98:99], v41 offset:41984
    v_mfma_f32_32x32x16_bf16 v[140:155], v[104:107], v[84:87], v[140:155]
    buffer_load_dwordx4 v14, s[32:35], s29 offen offset:2048 lds
    buffer_load_dwordx4 v15, s[32:35], s29 offen offset:3072 lds
    s_add_u32 s29, s29, 128
    v_mfma_f32_32x32x16_bf16 v[156:171], v[104:107], v[88:91], v[156:171]
    s_waitcnt lgkmcnt(0)
    v_mfma_f32_32x32x16_bf16 v[108:123], v[92:95], v[76:79], v[108:123]
    ds_read_b128 v[84:87], v35 offset:32768
    ds_read_b64_tr_b16 v[100:101], v40 offset:45056
    ds_read_b64_tr_b16 v[102:103], v40 offset:46080
    ds_read_b128 v[88:91], v35 offset:36864
    v_mfma_f32_32x32x16_bf16 v[124:139], v[92:95], v[80:83], v[124:139]
    ds_read_b64_tr_b16 v[104:105], v41 offset:45056
    ds_read_b64_tr_b16 v[106:107], v41 offset:46080
    s_add_u32 m0, s31, 16384
    s_nop 0
    buffer_load_dwordx4 v16, s[36:39], s30 offen offset:0 lds
    v_mfma_f32_32x32x16_bf16 v[140:155], v[96:99], v[76:79], v[140:155]
    buffer_load_dwordx4 v17, s[36:39], s30 offen offset:1024 lds
    buffer_load_dwordx2 v[216:217], v47, s[68:71], 0 offen offset:0 sc1
    buffer_load_dwordx2 v[218:219], v47, s[68:71], 0 offen offset:2048 sc1
    buffer_load_dwordx2 v[220:221], v47, s[68:71], s61 offen offset:0 sc1
    v_mfma_f32_32x32x16_bf16 v[156:171], v[96:99], v[80:83], v[156:171]
    buffer_load_dwordx2 v[222:223], v47, s[68:71], s61 offen offset:2048 sc1
    s_waitcnt vmcnt(22) lgkmcnt(0)
    s_barrier
    v_mfma_f32_32x32x16_bf16 v[108:123], v[100:103], v[84:87], v[108:123]
    ds_read_b128 v[76:79], v36 offset:0
    ds_read_b64_tr_b16 v[92:93], v42 offset:0
    ds_read_b64_tr_b16 v[94:95], v42 offset:1024
    ds_read_b128 v[80:83], v36 offset:4096
    v_mfma_f32_32x32x16_bf16 v[124:139], v[100:103], v[88:91], v[124:139]
    ds_read_b64_tr_b16 v[96:97], v43 offset:0
    ds_read_b64_tr_b16 v[98:99], v43 offset:1024
    buffer_load_dwordx4 v18, s[36:39], s30 offen offset:2048 lds
    buffer_load_dwordx4 v19, s[36:39], s30 offen offset:3072 lds
    v_mfma_f32_32x32x16_bf16 v[140:155], v[104:107], v[84:87], v[140:155]
    s_add_u32 s30, s30, 245760
    buffer_load_dwordx2 v[224:225], v47, s[68:71], s89 offen offset:0 sc1
    buffer_load_dwordx2 v[226:227], v47, s[68:71], s89 offen offset:2048 sc1
    buffer_load_dwordx2 v[228:229], v47, s[68:71], s90 offen offset:0 sc1
    v_mfma_f32_32x32x16_bf16 v[156:171], v[104:107], v[88:91], v[156:171]
    buffer_load_dwordx2 v[230:231], v47, s[68:71], s90 offen offset:2048 sc1
    s_waitcnt lgkmcnt(0)
    v_mfma_f32_32x32x16_bf16 v[108:123], v[92:95], v[76:79], v[108:123]
    ds_read_b128 v[84:87], v37 offset:0
    ds_read_b64_tr_b16 v[100:101], v42 offset:4096
    ds_read_b64_tr_b16 v[102:103], v42 offset:5120
    v_mfma_f32_32x32x16_bf16 v[124:139], v[92:95], v[80:83], v[124:139]
    ds_read_b128 v[88:91], v37 offset:4096
    ds_read_b64_tr_b16 v[104:105], v43 offset:4096
    ds_read_b64_tr_b16 v[106:107], v43 offset:5120
    v_mfma_f32_32x32x16_bf16 v[140:155], v[96:99], v[76:79], v[140:155]
    s_add_u32 m0, s31, 32768
    s_nop 0
    buffer_load_dwordx4 v12, s[32:35], s29 offen offset:0 lds
    buffer_load_dwordx4 v13, s[32:35], s29 offen offset:1024 lds
    v_mfma_f32_32x32x16_bf16 v[156:171], v[96:99], v[80:83], v[156:171]
    buffer_load_dwordx2 v[232:233], v48, s[68:71], 0 offen sc1
    s_waitcnt lgkmcnt(0)
    v_mfma_f32_32x32x16_bf16 v[108:123], v[100:103], v[84:87], v[108:123]
    ds_read_b128 v[76:79], v38 offset:0
    ds_read_b64_tr_b16 v[92:93], v42 offset:8192
    ds_read_b64_tr_b16 v[94:95], v42 offset:9216
    v_mfma_f32_32x32x16_bf16 v[124:139], v[100:103], v[88:91], v[124:139]
    ds_read_b128 v[80:83], v38 offset:4096
    ds_read_b64_tr_b16 v[96:97], v43 offset:8192
    ds_read_b64_tr_b16 v[98:99], v43 offset:9216
    v_mfma_f32_32x32x16_bf16 v[140:155], v[104:107], v[84:87], v[140:155]
    buffer_load_dwordx4 v14, s[32:35], s29 offen offset:2048 lds
    buffer_load_dwordx4 v15, s[32:35], s29 offen offset:3072 lds
    s_add_u32 s29, s29, 128
    v_mfma_f32_32x32x16_bf16 v[156:171], v[104:107], v[88:91], v[156:171]
    s_waitcnt lgkmcnt(0)
    v_mfma_f32_32x32x16_bf16 v[108:123], v[92:95], v[76:79], v[108:123]
    ds_read_b128 v[84:87], v39 offset:0
    ds_read_b64_tr_b16 v[100:101], v42 offset:12288
    ds_read_b64_tr_b16 v[102:103], v42 offset:13312
    v_mfma_f32_32x32x16_bf16 v[124:139], v[92:95], v[80:83], v[124:139]
    ds_read_b128 v[88:91], v39 offset:4096
    ds_read_b64_tr_b16 v[104:105], v43 offset:12288
    ds_read_b64_tr_b16 v[106:107], v43 offset:13312
    v_mfma_f32_32x32x16_bf16 v[140:155], v[96:99], v[76:79], v[140:155]
    s_add_u32 m0, s31, 49152
    s_nop 0
    buffer_load_dwordx4 v16, s[36:39], s30 offen offset:0 lds
    buffer_load_dwordx4 v17, s[36:39], s30 offen offset:1024 lds
    v_mfma_f32_32x32x16_bf16 v[156:171], v[96:99], v[80:83], v[156:171]
    s_waitcnt vmcnt(23) lgkmcnt(0)
    s_barrier
    v_mfma_f32_32x32x16_bf16 v[108:123], v[100:103], v[84:87], v[108:123]
    ds_read_b128 v[76:79], v36 offset:32768
    ds_read_b64_tr_b16 v[92:93], v42 offset:32768
    ds_read_b64_tr_b16 v[94:95], v42 offset:33792
    v_mfma_f32_32x32x16_bf16 v[124:139], v[100:103], v[88:91], v[124:139]
    ds_read_b128 v[80:83], v36 offset:36864
    ds_read_b64_tr_b16 v[96:97], v43 offset:32768
    ds_read_b64_tr_b16 v[98:99], v43 offset:33792
    v_mfma_f32_32x32x16_bf16 v[140:155], v[104:107], v[84:87], v[140:155]
    buffer_load_dwordx4 v18, s[36:39], s30 offen offset:2048 lds
    buffer_load_dwordx4 v19, s[36:39], s30 offen offset:3072 lds
    s_add_u32 s30, s30, 245760
    v_mfma_f32_32x32x16_bf16 v[156:171], v[104:107], v[88:91], v[156:171]
    buffer_load_dword v234, v8, s[64:67], 0 offen offset:128 sc1
    s_waitcnt lgkmcnt(0)
    v_mfma_f32_32x32x16_bf16 v[108:123], v[92:95], v[76:79], v[108:123]
    ds_read_b128 v[84:87], v37 offset:32768
    ds_read_b64_tr_b16 v[100:101], v42 offset:36864
    ds_read_b64_tr_b16 v[102:103], v42 offset:37888
    ds_read_b128 v[88:91], v37 offset:36864
    ds_read_b64_tr_b16 v[104:105], v43 offset:36864
    v_mfma_f32_32x32x16_bf16 v[124:139], v[92:95], v[80:83], v[124:139]
    ds_read_b64_tr_b16 v[106:107], v43 offset:37888
    v_lshrrev_b32 v4, 2, v1
    v_lshrrev_b32 v5, 4, v1
    v_xor_b32 v4, v4, v5
    v_and_b32 v4, 1, v4
    v_mfma_f32_32x32x16_bf16 v[140:155], v[96:99], v[76:79], v[140:155]
    v_cmp_eq_u32 vcc, 0, v4
    v_mov_b32 v5, 0x3f803f80
    s_add_u32 s76, s22, 0x1600000
    s_addc_u32 s77, s23, 0
    s_mov_b32 s78, 0x3c0000
    s_mov_b32 s79, 0x00020000
    v_cndmask_b32 v236, 0, v5, vcc
    v_mov_b32 v237, v236
    v_mfma_f32_32x32x16_bf16 v[156:171], v[96:99], v[80:83], v[156:171]
    v_mov_b32 v238, v236
    v_mov_b32 v239, v236
    s_waitcnt vmcnt(30)
    ds_read_b64_tr_b16 v[176:177], v23 offset:0
    ds_read_b64_tr_b16 v[178:179], v23 offset:1024
    s_waitcnt lgkmcnt(0)
    v_mfma_f32_32x32x16_bf16 v[108:123], v[100:103], v[84:87], v[108:123]
    ds_read_b128 v[76:79], v38 offset:32768
    ds_read_b64_tr_b16 v[92:93], v42 offset:40960
    ds_read_b64_tr_b16 v[94:95], v42 offset:41984
    v_mfma_f32_32x32x16_bf16 v[124:139], v[100:103], v[88:91], v[124:139]
    ds_read_b128 v[80:83], v38 offset:36864
    ds_read_b64_tr_b16 v[96:97], v43 offset:40960
    ds_read_b64_tr_b16 v[98:99], v43 offset:41984
    v_mfma_f32_32x32x16_bf16 v[140:155], v[104:107], v[84:87], v[140:155]
    v_mfma_f32_16x16x32_bf16 v[240:243], v[236:239], v[176:179], 0
    buffer_store_dwordx4 v[176:179], v6, s[76:79], s57 offen offset:0 sc1
    ds_read_b64_tr_b16 v[180:181], v23 offset:64
    v_mfma_f32_32x32x16_bf16 v[156:171], v[104:107], v[88:91], v[156:171]
    ds_read_b64_tr_b16 v[182:183], v23 offset:1088
    s_waitcnt lgkmcnt(0)
    v_mfma_f32_32x32x16_bf16 v[108:123], v[92:95], v[76:79], v[108:123]
    ds_read_b128 v[84:87], v39 offset:32768
    ds_read_b64_tr_b16 v[100:101], v42 offset:45056
    ds_read_b64_tr_b16 v[102:103], v42 offset:46080
    v_mfma_f32_32x32x16_bf16 v[124:139], v[92:95], v[80:83], v[124:139]
    ds_read_b128 v[88:91], v39 offset:36864
    ds_read_b64_tr_b16 v[104:105], v43 offset:45056
    ds_read_b64_tr_b16 v[106:107], v43 offset:46080
    v_mfma_f32_32x32x16_bf16 v[140:155], v[96:99], v[76:79], v[140:155]
    v_mfma_f32_16x16x32_bf16 v[244:247], v[236:239], v[180:183], 0
    buffer_store_dwordx4 v[180:183], v6, s[76:79], s58 offen offset:0 sc1
    ds_read_b64_tr_b16 v[184:185], v23 offset:2048
    v_mfma_f32_32x32x16_bf16 v[156:171], v[96:99], v[80:83], v[156:171]
    ds_read_b64_tr_b16 v[186:187], v23 offset:3072
    s_waitcnt vmcnt(16) lgkmcnt(0)
    s_barrier
    v_mfma_f32_32x32x16_bf16 v[108:123], v[100:103], v[84:87], v[108:123]
    ds_read_b128 v[76:79], v32 offset:0
    ds_read_b64_tr_b16 v[92:93], v40 offset:0
    ds_read_b64_tr_b16 v[94:95], v40 offset:1024
    v_mfma_f32_32x32x16_bf16 v[124:139], v[100:103], v[88:91], v[124:139]
    ds_read_b128 v[80:83], v32 offset:4096
    ds_read_b64_tr_b16 v[96:97], v41 offset:0
    ds_read_b64_tr_b16 v[98:99], v41 offset:1024
    v_mfma_f32_32x32x16_bf16 v[140:155], v[104:107], v[84:87], v[140:155]
    v_mfma_f32_16x16x32_bf16 v[240:243], v[236:239], v[184:187], v[240:243]
    buffer_store_dwordx4 v[184:187], v6, s[76:79], s57 offen offset:2048 sc1
    ds_read_b64_tr_b16 v[188:189], v23 offset:2112
    v_mfma_f32_32x32x16_bf16 v[156:171], v[104:107], v[88:91], v[156:171]
    ds_read_b64_tr_b16 v[190:191], v23 offset:3136
    s_add_u32 s80, s22, 0x1a00000
    s_addc_u32 s81, s23, 0
    s_mov_b32 s82, 0x1e0000
    s_mov_b32 s83, 0x00020000
    s_waitcnt lgkmcnt(0)
    v_mfma_f32_32x32x16_bf16 v[108:123], v[92:95], v[76:79], v[108:123]
    ds_read_b128 v[84:87], v33 offset:0
    ds_read_b64_tr_b16 v[100:101], v40 offset:4096
    ds_read_b64_tr_b16 v[102:103], v40 offset:5120
    v_mfma_f32_32x32x16_bf16 v[124:139], v[92:95], v[80:83], v[124:139]
    ds_read_b128 v[88:91], v33 offset:4096
    ds_read_b64_tr_b16 v[104:105], v41 offset:4096
    ds_read_b64_tr_b16 v[106:107], v41 offset:5120
    v_mfma_f32_32x32x16_bf16 v[140:155], v[96:99], v[76:79], v[140:155]
    v_mfma_f32_16x16x32_bf16 v[244:247], v[236:239], v[188:191], v[244:247]
    buffer_store_dwordx4 v[188:191], v6, s[76:79], s58 offen offset:2048 sc1
    ds_read_b64_tr_b16 v[192:193], v24 offset:4096
    v_mfma_f32_32x32x16_bf16 v[156:171], v[96:99], v[80:83], v[156:171]
    ds_read_b64_tr_b16 v[194:195], v24 offset:4608
    s_waitcnt lgkmcnt(0)
    v_mfma_f32_32x32x16_bf16 v[108:123], v[100:103], v[84:87], v[108:123]
    ds_read_b128 v[76:79], v34 offset:0
    ds_read_b64_tr_b16 v[92:93], v40 offset:8192
    ds_read_b64_tr_b16 v[94:95], v40 offset:9216
    ds_read_b128 v[80:83], v34 offset:4096
    ds_read_b64_tr_b16 v[96:97], v41 offset:8192
    v_mfma_f32_32x32x16_bf16 v[124:139], v[100:103], v[88:91], v[124:139]
    ds_read_b64_tr_b16 v[98:99], v41 offset:9216
    buffer_store_dwordx4 v[192:195], v6, s[80:83], s59 offen sc1
    ds_read_b64_tr_b16 v[196:197], v24 offset:4128
    ds_read_b64_tr_b16 v[198:199], v24 offset:4640
    s_waitcnt vmcnt(12)
    v_min3_u32 v2, v217, v219, v221
    v_max3_u32 v3, v217, v219, v221
    v_min3_u32 v2, v2, v223, v225
    v_max3_u32 v3, v3, v223, v225
    v_min3_u32 v2, v2, v227, v229
    v_max3_u32 v3, v3, v227, v229
    v_min3_u32 v2, v2, v231, v233
    v_max3_u32 v3, v3, v231, v233
    v_cmp_ne_u32 s[92:93], s51, v2
    v_cmp_ne_u32 s[94:95], s51, v3
    s_nop 1
    s_or_b64 s[92:93], s[92:93], s[94:95]
    s_cbranch_scc1 L_k1_gslow
L_k1_gok:
    v_mfma_f32_32x32x16_bf16 v[140:155], v[104:107], v[84:87], v[140:155]
    v_add_f32 v216, v216, v218
    v_add_f32 v216, v216, v220
    v_add_f32 v216, v216, v222
    v_add_f32 v216, v216, v224
    v_add_f32 v216, v216, v226
    v_mfma_f32_32x32x16_bf16 v[156:171], v[104:107], v[88:91], v[156:171]
    v_add_f32 v216, v216, v228
    v_add_f32 v216, v216, v230
    s_waitcnt lgkmcnt(0)
    v_mfma_f32_32x32x16_bf16 v[108:123], v[92:95], v[76:79], v[108:123]
    ds_read_b128 v[84:87], v35 offset:0
    ds_read_b64_tr_b16 v[100:101], v40 offset:12288
    ds_read_b64_tr_b16 v[102:103], v40 offset:13312
    ds_read_b128 v[88:91], v35 offset:4096
    ds_read_b64_tr_b16 v[104:105], v41 offset:12288
    v_mfma_f32_32x32x16_bf16 v[124:139], v[92:95], v[80:83], v[124:139]
    ds_read_b64_tr_b16 v[106:107], v41 offset:13312
    buffer_store_dwordx4 v[196:199], v6, s[80:83], s60 offen sc1
    v_cmp_gt_u32 vcc, 32, v1
    s_add_u32 s84, s22, 0x1420000
    s_addc_u32 s85, s23, 0
    s_mov_b32 s86, 0xf000
    s_mov_b32 s87, 0x00020000
    v_cndmask_b32 v248, v244, v240, vcc
    v_mfma_f32_32x32x16_bf16 v[140:155], v[96:99], v[76:79], v[140:155]
    ds_write_b32 v28, v248
    v_mov_b32 v217, v216
    ds_write_b32 v49, v232 offset:512
    s_nop 0
    v_permlane32_swap_b32 v216, v217
    v_mfma_f32_32x32x16_bf16 v[156:171], v[96:99], v[80:83], v[156:171]
    v_add_f32 v216, v216, v217
    ds_write_b32 v49, v216
    s_waitcnt vmcnt(7) lgkmcnt(0)
    s_barrier
    v_mfma_f32_32x32x16_bf16 v[108:123], v[100:103], v[84:87], v[108:123]
    ds_read_b128 v[76:79], v32 offset:32768
    ds_read_b64_tr_b16 v[92:93], v40 offset:32768
    ds_read_b64_tr_b16 v[94:95], v40 offset:33792
    ds_read_b128 v[80:83], v32 offset:36864
    v_mfma_f32_32x32x16_bf16 v[124:139], v[100:103], v[88:91], v[124:139]
    ds_read_b64_tr_b16 v[96:97], v41 offset:32768
    ds_read_b64_tr_b16 v[98:99], v41 offset:33792
    ds_read_b32 v240, v27 offset:0
    ds_read_b32 v241, v27 offset:256
    v_mfma_f32_32x32x16_bf16 v[140:155], v[104:107], v[84:87], v[140:155]
    ds_read_b32 v242, v27 offset:512
    ds_read_b32 v243, v27 offset:768
    s_lshl_b32 s27, s24, 28
    v_lshlrev_b32 v249, 2, v1
    v_mfma_f32_32x32x16_bf16 v[156:171], v[104:107], v[88:91], v[156:171]
    v_add_u32 v249, s27, v249
    s_waitcnt lgkmcnt(0)
    v_mfma_f32_32x32x16_bf16 v[108:123], v[92:95], v[76:79], v[108:123]
    ds_read_b128 v[84:87], v33 offset:32768
    ds_read_b64_tr_b16 v[100:101], v40 offset:36864
    ds_read_b64_tr_b16 v[102:103], v40 offset:37888
    ds_read_b128 v[88:91], v33 offset:36864
    v_mfma_f32_32x32x16_bf16 v[124:139], v[92:95], v[80:83], v[124:139]
    ds_read_b64_tr_b16 v[104:105], v41 offset:36864
    ds_read_b64_tr_b16 v[106:107], v41 offset:37888
    v_add_f32 v240, v240, v241
    v_add_f32 v242, v242, v243
    v_mfma_f32_32x32x16_bf16 v[140:155], v[96:99], v[76:79], v[140:155]
    v_add_f32 v248, v240, v242
    buffer_store_dword v248, v249, s[84:87], s55 offen sc1
    ds_read_b32 v72, v45 offset:0
    ds_read_b32 v73, v45 offset:128
    v_mfma_f32_32x32x16_bf16 v[156:171], v[96:99], v[80:83], v[156:171]
    ds_read_b32 v74, v46 offset:0
    ds_read_b32 v75, v46 offset:128
    v_cmp_gt_u32 vcc, 32, v1
    s_waitcnt lgkmcnt(0)
    v_mfma_f32_32x32x16_bf16 v[108:123], v[100:103], v[84:87], v[108:123]
    ds_read_b128 v[76:79], v34 offset:32768
    ds_read_b64_tr_b16 v[92:93], v40 offset:40960
    ds_read_b64_tr_b16 v[94:95], v40 offset:41984
    ds_read_b128 v[80:83], v34 offset:36864
    ds_read_b64_tr_b16 v[96:97], v41 offset:40960
    v_mfma_f32_32x32x16_bf16 v[124:139], v[100:103], v[88:91], v[124:139]
    ds_read_b64_tr_b16 v[98:99], v41 offset:41984
    v_and_b32 v2, 0xffff0000, v72
    v_sub_f32 v2, v72, v2
    v_and_b32 v3, 0xffff0000, v2
    v_sub_f32 v3, v2, v3
    v_mfma_f32_32x32x16_bf16 v[140:155], v[104:107], v[84:87], v[140:155]
    v_perm_b32 v52, v2, v72, s46
    v_lshrrev_b32 v53, 16, v3
    v_and_b32 v4, 0xffff0000, v73
    v_sub_f32 v4, v73, v4
    v_and_b32 v5, 0xffff0000, v4
    v_mfma_f32_32x32x16_bf16 v[156:171], v[104:107], v[88:91], v[156:171]
    v_sub_f32 v5, v4, v5
    v_perm_b32 v56, v4, v73, s46
    v_lshrrev_b32 v57, 16, v5
    s_waitcnt lgkmcnt(0)
    v_mfma_f32_32x32x16_bf16 v[108:123], v[92:95], v[76:79], v[108:123]
    ds_read_b128 v[84:87], v35 offset:32768
    ds_read_b64_tr_b16 v[100:101], v40 offset:45056
    ds_read_b64_tr_b16 v[102:103], v40 offset:46080
    ds_read_b128 v[88:91], v35 offset:36864
    ds_read_b64_tr_b16 v[104:105], v41 offset:45056
    v_mfma_f32_32x32x16_bf16 v[124:139], v[92:95], v[80:83], v[124:139]
    ds_read_b64_tr_b16 v[106:107], v41 offset:46080
    v_and_b32 v2, s50, v74
    v_rcp_f32 v2, v2
    v_cndmask_b32 v3, 0, v74, vcc
    v_mul_f32 v68, s47, v2
    v_mfma_f32_32x32x16_bf16 v[140:155], v[96:99], v[76:79], v[140:155]
    v_perm_b32 v60, v3, v3, s88
    v_and_b32 v61, 0xffff, v3
    v_mov_b32 v69, v68
    v_and_b32 v2, s50, v75
    v_rcp_f32 v2, v2
    v_mfma_f32_32x32x16_bf16 v[156:171], v[96:99], v[80:83], v[156:171]
    v_cndmask_b32 v3, 0, v75, vcc
    v_mul_f32 v70, s47, v2
    v_perm_b32 v64, v3, v3, s88
    v_and_b32 v65, 0xffff, v3
    v_mov_b32 v71, v70
    s_waitcnt lgkmcnt(0)
    s_barrier
    v_mfma_f32_32x32x16_bf16 v[108:123], v[100:103], v[84:87], v[108:123]
    v_mfma_f32_32x32x16_bf16 v[108:123], v[52:55], v[60:63], v[108:123]
    v_mfma_f32_32x32x16_bf16 v[124:139], v[100:103], v[88:91], v[124:139]
    v_mfma_f32_32x32x16_bf16 v[124:139], v[52:55], v[64:67], v[124:139]
    v_mfma_f32_32x32x16_bf16 v[140:155], v[104:107], v[84:87], v[140:155]
    s_nop 8
    v_pk_mul_f32 v[108:109], v[108:109], v[68:69]
    v_pk_mul_f32 v[110:111], v[110:111], v[68:69]
    v_pk_mul_f32 v[112:113], v[112:113], v[68:69]
    v_pk_mul_f32 v[114:115], v[114:115], v[68:69]
    v_mfma_f32_32x32x16_bf16 v[140:155], v[56:59], v[60:63], v[140:155]
    v_cvt_pk_bf16_f32 v108, v108, v109
    v_cvt_pk_bf16_f32 v109, v110, v111
    v_cvt_pk_bf16_f32 v110, v112, v113
    v_cvt_pk_bf16_f32 v111, v114, v115
    buffer_store_dwordx4 v[108:111], v44, s[40:43], s48 offen offset:0 sc1
    v_mfma_f32_32x32x16_bf16 v[156:171], v[104:107], v[88:91], v[156:171]
    v_pk_mul_f32 v[116:117], v[116:117], v[68:69]
    v_pk_mul_f32 v[118:119], v[118:119], v[68:69]
    v_pk_mul_f32 v[120:121], v[120:121], v[68:69]
    v_pk_mul_f32 v[122:123], v[122:123], v[68:69]
    v_mfma_f32_32x32x16_bf16 v[156:171], v[56:59], v[64:67], v[156:171]
    v_cvt_pk_bf16_f32 v116, v116, v117
    v_cvt_pk_bf16_f32 v117, v118, v119
    v_cvt_pk_bf16_f32 v118, v120, v121
    v_cvt_pk_bf16_f32 v119, v122, v123
    buffer_store_dwordx4 v[116:119], v44, s[40:43], s48 offen offset:1024 sc1
    v_pk_mul_f32 v[124:125], v[124:125], v[70:71]
    v_pk_mul_f32 v[126:127], v[126:127], v[70:71]
    v_pk_mul_f32 v[128:129], v[128:129], v[70:71]
    v_pk_mul_f32 v[130:131], v[130:131], v[70:71]
    v_cvt_pk_bf16_f32 v124, v124, v125
    v_cvt_pk_bf16_f32 v125, v126, v127
    v_cvt_pk_bf16_f32 v126, v128, v129
    v_cvt_pk_bf16_f32 v127, v130, v131
    buffer_store_dwordx4 v[124:127], v44, s[40:43], s49 offen offset:0 sc1
    v_pk_mul_f32 v[132:133], v[132:133], v[70:71]
    v_pk_mul_f32 v[134:135], v[134:135], v[70:71]
    v_pk_mul_f32 v[136:137], v[136:137], v[70:71]
    v_pk_mul_f32 v[138:139], v[138:139], v[70:71]
    v_cvt_pk_bf16_f32 v132, v132, v133
    v_cvt_pk_bf16_f32 v133, v134, v135
    v_cvt_pk_bf16_f32 v134, v136, v137
    v_cvt_pk_bf16_f32 v135, v138, v139
    buffer_store_dwordx4 v[132:135], v44, s[40:43], s49 offen offset:1024 sc1
    v_pk_mul_f32 v[140:141], v[140:141], v[68:69]
    v_pk_mul_f32 v[142:143], v[142:143], v[68:69]
    v_pk_mul_f32 v[144:145], v[144:145], v[68:69]
    v_pk_mul_f32 v[146:147], v[146:147], v[68:69]
    v_cvt_pk_bf16_f32 v140, v140, v141
    v_cvt_pk_bf16_f32 v141, v142, v143
    v_cvt_pk_bf16_f32 v142, v144, v145
    v_cvt_pk_bf16_f32 v143, v146, v147
    buffer_store_dwordx4 v[140:143], v44, s[40:43], s48 offen offset:2048 sc1
    v_pk_mul_f32 v[148:149], v[148:149], v[68:69]
    v_pk_mul_f32 v[150:151], v[150:151], v[68:69]
    v_pk_mul_f32 v[152:153], v[152:153], v[68:69]
    v_pk_mul_f32 v[154:155], v[154:155], v[68:69]
    v_cvt_pk_bf16_f32 v148, v148, v149
    v_cvt_pk_bf16_f32 v149, v150, v151
    v_cvt_pk_bf16_f32 v150, v152, v153
    v_cvt_pk_bf16_f32 v151, v154, v155
    buffer_store_dwordx4 v[148:151], v44, s[40:43], s48 offen offset:3072 sc1
    v_pk_mul_f32 v[156:157], v[156:157], v[70:71]
    v_pk_mul_f32 v[158:159], v[158:159], v[70:71]
    v_pk_mul_f32 v[160:161], v[160:161], v[70:71]
    v_pk_mul_f32 v[162:163], v[162:163], v[70:71]
    v_cvt_pk_bf16_f32 v156, v156, v157
    v_cvt_pk_bf16_f32 v157, v158, v159
    v_cvt_pk_bf16_f32 v158, v160, v161
    v_cvt_pk_bf16_f32 v159, v162, v163
    buffer_store_dwordx4 v[156:159], v44, s[40:43], s49 offen offset:2048 sc1
    v_pk_mul_f32 v[164:165], v[164:165], v[70:71]
    v_pk_mul_f32 v[166:167], v[166:167], v[70:71]
    v_pk_mul_f32 v[168:169], v[168:169], v[70:71]
    v_pk_mul_f32 v[170:171], v[170:171], v[70:71]
    v_cvt_pk_bf16_f32 v164, v164, v165
    v_cvt_pk_bf16_f32 v165, v166, v167
    v_cvt_pk_bf16_f32 v166, v168, v169
    v_cvt_pk_bf16_f32 v167, v170, v171
    buffer_store_dwordx4 v[164:167], v44, s[40:43], s49 offen offset:3072 sc1
    s_lshl_b32 s27, s25, 4
    s_add_u32 s27, s27, s26
    s_lshl_b32 s27, s27, 7
    s_add_u32 s3, s27, 90112
    s_waitcnt vmcnt(15)
    v_readfirstlane_b32 s27, v234
    s_nop 1
    s_cmp_lt_u32 s27, 64
    s_cbranch_scc1 L_k1_zslow
L_k1_zok:
    s_lshl_b32 s27, s25, 7
    s_add_u32 s27, s27, 122880
    s_waitcnt vmcnt(8)
    s_mov_b64 exec, 1
    buffer_atomic_add v9, v8, s[72:75], s27 offen sc1
    s_mov_b64 exec, -1
    s_branch L_p2_start
L_k1_zslow:
    s_mov_b32 s91, 0x20000
L_k1_zslow1:
    s_sleep 16
    buffer_load_dword v234, v8, s[64:67], 0 offen offset:128 sc1
    s_waitcnt vmcnt(0)
    v_readfirstlane_b32 s27, v234
    s_sub_u32 s91, s91, 1
    s_cmp_eq_u32 s91, 0
    s_cbranch_scc1 L_k1_zok
    s_cmp_lt_u32 s27, 64
    s_cbranch_scc1 L_k1_zslow1
    s_branch L_k1_zok
L_k1_gslow:
    s_mov_b32 s91, 0x10000
L_k1_gslow1:
    s_sleep 8
    buffer_load_dwordx2 v[216:217], v47, s[68:71], 0 offen offset:0 sc1
    buffer_load_dwordx2 v[218:219], v47, s[68:71], 0 offen offset:2048 sc1
    buffer_load_dwordx2 v[220:221], v47, s[68:71], s61 offen offset:0 sc1
    buffer_load_dwordx2 v[222:223], v47, s[68:71], s61 offen offset:2048 sc1
    buffer_load_dwordx2 v[224:225], v47, s[68:71], s89 offen offset:0 sc1
    buffer_load_dwordx2 v[226:227], v47, s[68:71], s89 offen offset:2048 sc1
    buffer_load_dwordx2 v[228:229], v47, s[68:71], s90 offen offset:0 sc1
    buffer_load_dwordx2 v[230:231], v47, s[68:71], s90 offen offset:2048 sc1
    buffer_load_dwordx2 v[232:233], v48, s[68:71], 0 offen sc1
    s_sub_u32 s91, s91, 1
    s_cmp_eq_u32 s91, 0
    s_cbranch_scc1 L_k1_gslow2
    s_waitcnt vmcnt(0)
    v_min3_u32 v2, v217, v219, v221
    v_max3_u32 v3, v217, v219, v221
    v_min3_u32 v2, v2, v223, v225
    v_max3_u32 v3, v3, v223, v225
    v_min3_u32 v2, v2, v227, v229
    v_max3_u32 v3, v3, v227, v229
    v_min3_u32 v2, v2, v231, v233
    v_max3_u32 v3, v3, v231, v233
    v_cmp_ne_u32 s[92:93], s51, v2
    v_cmp_ne_u32 s[94:95], s51, v3
    s_nop 1
    s_or_b64 s[92:93], s[92:93], s[94:95]
    s_cbranch_scc1 L_k1_gslow1
L_k1_gslow2:
    s_waitcnt vmcnt(0)
    s_branch L_k1_gok
L_k1_spare:
    v_lshrrev_b32 v3, 5, v1
    v_and_b32 v2, 31, v1
    v_mul_u32_u24 v4, 1280, v3
    v_lshl_add_u32 v20, v2, 4, v4
    v_lshl_add_u32 v21, v2, 3, v4
    s_lshl_b32 s27, s25, 4
    s_add_u32 s27, s27, s26
    s_lshl_b32 s27, s27, 2
    s_add_u32 s27, s27, s24
    s_lshl_b32 s48, s27, 4
    s_mul_i32 s49, s27, 2560
    s_waitcnt lgkmcnt(0)
    s_mov_b32 s32, s4
    s_mov_b32 s33, s5
    s_mov_b32 s34, 0x280000
    s_mov_b32 s35, 0x00020000
    s_mov_b32 s64, s20
    s_mov_b32 s65, s21
    s_mov_b32 s66, 0x100
    s_mov_b32 s67, 0x00020000
    s_and_b32 s27, s25, 3
    s_add_u32 s27, s27, s24
    s_lshl_b32 s27, s27, 12
    v_mov_b32 v3, s27
    s_or_b32 s51, s62, 1
    v_mov_b32 v16, s51
    v_mov_b32 v17, 0
    buffer_load_dwordx4 v[176:179], v20, s[32:35], s49 offen
    buffer_load_dwordx4 v[180:183], v20, s[32:35], s49 offen offset:512
    buffer_load_dwordx2 v[184:185], v21, s[32:35], s49 offen offset:1024
    s_mov_b64 exec, 1
    buffer_atomic_cmpswap v[16:17], v3, s[64:67], 0 offen sc1
    s_mov_b64 exec, -1
    v_mov_b32 v12, 0
    v_mov_b32 v13, 0
    v_mov_b32 v14, 0
    v_mov_b32 v15, 0
    v_lshlrev_b32 v2, 4, v0
    s_lshl_b32 s27, s25, 13
    s_add_u32 s72, s22, 0x1c00000
    s_addc_u32 s73, s23, 0
    s_mov_b32 s74, 0x20000
    s_mov_b32 s75, 0x00020000
    buffer_store_dwordx4 v[12:15], v2, s[72:75], s27 offen sc1
    s_add_u32 s27, s27, 4096
    buffer_store_dwordx4 v[12:15], v2, s[72:75], s27 offen sc1
    s_mov_b32 s64, s20
    s_mov_b32 s65, s21
    s_mov_b32 s66, 0x100
    s_mov_b32 s67, 0x00020000
    s_add_u32 s68, s22, 0x1c40000
    s_addc_u32 s69, s23, 0
    s_mov_b32 s70, 0x40000
    s_mov_b32 s71, 0x00020000
    s_lshl_b32 s44, s25, 2
    s_add_u32 s44, s44, s24
    v_lshrrev_b32 v2, 3, v1
    v_and_b32 v3, 7, v1
    v_lshlrev_b32 v3, 4, v3
    v_mul_u32_u24 v23, 1280, v2
    v_add_u32 v23, v23, v3
    v_lshrrev_b32 v4, 2, v2
    v_mul_u32_u24 v4, 16, v4
    v_add3_u32 v4, v4, v2, 16
    v_mul_u32_u24 v24, 1280, v4
    v_add_u32 v24, v24, v3
    v_lshrrev_b32 v2, 5, v1
    v_bfe_u32 v3, v1, 4, 1
    v_lshlrev_b32 v2, 2, v2
    v_add_u32 v2, v2, v3
    v_bfe_u32 v3, v1, 2, 2
    v_lshl_add_u32 v2, v2, 2, v3
    v_lshlrev_b32 v2, 7, v2
    v_and_b32 v3, 3, v1
    v_lshl_add_u32 v2, v3, 3, v2
    s_mul_i32 s31, s24, 40960
    v_add_u32 v25, s31, v2
    s_waitcnt vmcnt(3)
    buffer_load_dword v10, v8, s[64:67], 0 offen sc1
    v_and_b32 v208, s50, v176
    v_lshlrev_b32 v209, 16, v176
    v_mov_b32 v200, v208
    v_mov_b32 v201, v209
    v_mul_f32 v202, v208, v208
    v_mul_f32 v203, v209, v209
    v_and_b32 v210, s50, v177
    v_lshlrev_b32 v211, 16, v177
    v_add_f32 v200, v200, v210
    v_fmac_f32 v202, v210, v210
    v_add_f32 v201, v201, v211
    v_fmac_f32 v203, v211, v211
    v_and_b32 v212, s50, v178
    v_lshlrev_b32 v213, 16, v178
    v_add_f32 v200, v200, v212
    v_fmac_f32 v202, v212, v212
    v_add_f32 v201, v201, v213
    v_fmac_f32 v203, v213, v213
    v_and_b32 v214, s50, v179
    v_lshlrev_b32 v215, 16, v179
    v_add_f32 v200, v200, v214
    v_fmac_f32 v202, v214, v214
    v_add_f32 v201, v201, v215
    v_fmac_f32 v203, v215, v215
    v_and_b32 v208, s50, v180
    v_lshlrev_b32 v209, 16, v180
    v_add_f32 v200, v200, v208
    v_fmac_f32 v202, v208, v208
    v_add_f32 v201, v201, v209
    v_fmac_f32 v203, v209, v209
    v_and_b32 v210, s50, v181
    v_lshlrev_b32 v211, 16, v181
    v_add_f32 v200, v200, v210
    v_fmac_f32 v202, v210, v210
    v_add_f32 v201, v201, v211
    v_fmac_f32 v203, v211, v211
    v_and_b32 v212, s50, v182
    v_lshlrev_b32 v213, 16, v182
    v_add_f32 v200, v200, v212
    v_fmac_f32 v202, v212, v212
    v_add_f32 v201, v201, v213
    v_fmac_f32 v203, v213, v213
    v_and_b32 v214, s50, v183
    v_lshlrev_b32 v215, 16, v183
    v_add_f32 v200, v200, v214
    v_fmac_f32 v202, v214, v214
    v_add_f32 v201, v201, v215
    v_fmac_f32 v203, v215, v215
    v_and_b32 v208, s50, v184
    v_lshlrev_b32 v209, 16, v184
    v_add_f32 v200, v200, v208
    v_fmac_f32 v202, v208, v208
    v_add_f32 v201, v201, v209
    v_fmac_f32 v203, v209, v209
    v_and_b32 v210, s50, v185
    v_lshlrev_b32 v211, 16, v185
    v_add_f32 v200, v200, v210
    v_fmac_f32 v202, v210, v210
    v_add_f32 v201, v201, v211
    v_fmac_f32 v203, v211, v211
    v_add_f32 v200, v200, v201
    v_add_f32 v202, v202, v203
    s_nop 0
    v_add_f32_dpp v200, v200, v200 row_ror:8 row_mask:0xf bank_mask:0xf
    v_add_f32_dpp v202, v202, v202 row_ror:8 row_mask:0xf bank_mask:0xf
    s_nop 0
    v_add_f32_dpp v200, v200, v200 row_ror:4 row_mask:0xf bank_mask:0xf
    v_add_f32_dpp v202, v202, v202 row_ror:4 row_mask:0xf bank_mask:0xf
    s_nop 0
    v_add_f32_dpp v200, v200, v200 row_ror:2 row_mask:0xf bank_mask:0xf
    v_add_f32_dpp v202, v202, v202 row_ror:2 row_mask:0xf bank_mask:0xf
    s_nop 0
    v_add_f32_dpp v200, v200, v200 row_ror:1 row_mask:0xf bank_mask:0xf
    v_add_f32_dpp v202, v202, v202 row_ror:1 row_mask:0xf bank_mask:0xf
    v_mov_b32 v201, v200
    v_mov_b32 v203, v202
    s_nop 0
    v_permlane16_swap_b32 v200, v201
    v_permlane16_swap_b32 v202, v203
    v_add_f32 v200, v200, v201
    v_add_f32 v202, v202, v203
    v_mul_f32 v200, 0x3acccccd, v200
    v_mul_f32 v202, 0x3acccccd, v202
    v_fma_f32 v202, -v200, v200, v202
    v_max_f32 v202, 0, v202
    v_cvt_pk_bf16_f32 v208, v200, v200
    v_lshlrev_b32 v208, 16, v208
    v_xor_b32 v201, 0x80000000, v208
    v_cvt_pk_bf16_f32 v202, v202, v202
    v_lshlrev_b32 v202, 16, v202
    v_add_f32 v202, 0x3727c5ac, v202
    v_cvt_pk_bf16_f32 v202, v202, v202
    v_lshlrev_b32 v202, 16, v202
    v_sqrt_f32 v202, v202
    s_nop 0
    v_cvt_pk_bf16_f32 v202, v202, v202
    v_lshlrev_b32 v202, 16, v202
    v_perm_b32 v204, v202, v201, s46
    v_lshrrev_b32 v20, 5, v1
    v_lshlrev_b32 v20, 3, v20
    v_lshl_add_u32 v20, v1, 27, v20
    s_waitcnt vmcnt(0)
    v_readfirstlane_b32 s51, v10
    s_nop 1
    s_cmp_eq_u32 s51, 0
    s_cbranch_scc1 L_k1_eps_s
L_k1_epok_s:
    v_mov_b32 v205, s51
    buffer_store_dwordx2 v[204:205], v20, s[68:71], s48 offen sc1
    s_mov_b64 exec, 1
    buffer_atomic_add v9, v8, s[64:67], 0 offen offset:128 sc1
    s_mov_b64 exec, -1
    s_mov_b32 s76, s8
    s_mov_b32 s77, s9
    s_mov_b32 s78, 0xc8000
    s_mov_b32 s79, 0x00020000
    s_add_u32 s40, s22, 0x1500000
    s_addc_u32 s41, s23, 0
    s_mov_b32 s42, 0xc8000
    s_mov_b32 s43, 0x00020000
    s_add_u32 s27, s44, 0
    s_min_u32 s27, s27, 199
    s_mul_i32 s45, s27, 205
    s_lshr_b32 s45, s45, 11
    s_mul_i32 s28, s45, 10
    s_sub_u32 s47, s27, s28
    s_mov_b32 s54, s45
    s_mov_b32 s55, s47
    s_mul_i32 s27, s45, 205
    s_lshr_b32 s27, s27, 10
    s_mul_i32 s28, s27, 5
    s_sub_u32 s28, s45, s28
    s_mul_i32 s27, s27, 204800
    s_lshl_b32 s47, s47, 7
    s_add_u32 s27, s27, s47
    s_mul_i32 s47, s28, 51200
    s_cmp_eq_u32 s28, 4
    s_cselect_b32 s47, 0, s47
    s_cselect_b64 vcc, -1, 0
    s_add_u32 s27, s27, s47
    v_cndmask_b32 v2, v23, v24, vcc
    s_cmp_eq_u32 s28, 4
    s_mov_b32 s47, 0
    s_cmov_b32 s47, 0
    s_add_u32 s47, s47, s27
    s_add_u32 m0, s31, 0
    s_nop 0
    buffer_load_dwordx4 v2, s[76:79], s47 offen lds
    s_cmp_eq_u32 s28, 4
    s_mov_b32 s47, 10240
    s_cmov_b32 s47, 51200
    s_add_u32 s47, s47, s27
    s_add_u32 m0, s31, 1024
    s_nop 0
    buffer_load_dwordx4 v2, s[76:79], s47 offen lds
    s_cmp_eq_u32 s28, 4
    s_mov_b32 s47, 25600
    s_cmov_b32 s47, 102400
    s_add_u32 s47, s47, s27
    s_add_u32 m0, s31, 2048
    s_nop 0
    buffer_load_dwordx4 v2, s[76:79], s47 offen lds
    s_cmp_eq_u32 s28, 4
    s_mov_b32 s47, 35840
    s_cmov_b32 s47, 153600
    s_add_u32 s47, s47, s27
    s_add_u32 m0, s31, 3072
    s_nop 0
    buffer_load_dwordx4 v2, s[76:79], s47 offen lds
    s_add_u32 s27, s44, 64
    s_min_u32 s27, s27, 199
    s_mul_i32 s45, s27, 205
    s_lshr_b32 s45, s45, 11
    s_mul_i32 s28, s45, 10
    s_sub_u32 s47, s27, s28
    s_mov_b32 s56, s45
    s_mov_b32 s57, s47
    s_mul_i32 s27, s45, 205
    s_lshr_b32 s27, s27, 10
    s_mul_i32 s28, s27, 5
    s_sub_u32 s28, s45, s28
    s_mul_i32 s27, s27, 204800
    s_lshl_b32 s47, s47, 7
    s_add_u32 s27, s27, s47
    s_mul_i32 s47, s28, 51200
    s_cmp_eq_u32 s28, 4
    s_cselect_b32 s47, 0, s47
    s_cselect_b64 vcc, -1, 0
    s_add_u32 s27, s27, s47
    v_cndmask_b32 v2, v23, v24, vcc
    s_cmp_eq_u32 s28, 4
    s_mov_b32 s47, 0
    s_cmov_b32 s47, 0
    s_add_u32 s47, s47, s27
    s_add_u32 m0, s31, 4096
    s_nop 0
    buffer_load_dwordx4 v2, s[76:79], s47 offen lds
    s_cmp_eq_u32 s28, 4
    s_mov_b32 s47, 10240
    s_cmov_b32 s47, 51200
    s_add_u32 s47, s47, s27
    s_add_u32 m0, s31, 5120
    s_nop 0
    buffer_load_dwordx4 v2, s[76:79], s47 offen lds
    s_cmp_eq_u32 s28, 4
    s_mov_b32 s47, 25600
    s_cmov_b32 s47, 102400
    s_add_u32 s47, s47, s27
    s_add_u32 m0, s31, 6144
    s_nop 0
    buffer_load_dwordx4 v2, s[76:79], s47 offen lds
    s_cmp_eq_u32 s28, 4
    s_mov_b32 s47, 35840
    s_cmov_b32 s47, 153600
    s_add_u32 s47, s47, s27
    s_add_u32 m0, s31, 7168
    s_nop 0
    buffer_load_dwordx4 v2, s[76:79], s47 offen lds
    s_add_u32 s27, s44, 128
    s_min_u32 s27, s27, 199
    s_mul_i32 s45, s27, 205
    s_lshr_b32 s45, s45, 11
    s_mul_i32 s28, s45, 10
    s_sub_u32 s47, s27, s28
    s_mov_b32 s58, s45
    s_mov_b32 s59, s47
    s_mul_i32 s27, s45, 205
    s_lshr_b32 s27, s27, 10
    s_mul_i32 s28, s27, 5
    s_sub_u32 s28, s45, s28
    s_mul_i32 s27, s27, 204800
    s_lshl_b32 s47, s47, 7
    s_add_u32 s27, s27, s47
    s_mul_i32 s47, s28, 51200
    s_cmp_eq_u32 s28, 4
    s_cselect_b32 s47, 0, s47
    s_cselect_b64 vcc, -1, 0
    s_add_u32 s27, s27, s47
    v_cndmask_b32 v2, v23, v24, vcc
    s_cmp_eq_u32 s28, 4
    s_mov_b32 s47, 0
    s_cmov_b32 s47, 0
    s_add_u32 s47, s47, s27
    s_add_u32 m0, s31, 8192
    s_nop 0
    buffer_load_dwordx4 v2, s[76:79], s47 offen lds
    s_cmp_eq_u32 s28, 4
    s_mov_b32 s47, 10240
    s_cmov_b32 s47, 51200
    s_add_u32 s47, s47, s27
    s_add_u32 m0, s31, 9216
    s_nop 0
    buffer_load_dwordx4 v2, s[76:79], s47 offen lds
    s_cmp_eq_u32 s28, 4
    s_mov_b32 s47, 25600
    s_cmov_b32 s47, 102400
    s_add_u32 s47, s47, s27
    s_add_u32 m0, s31, 10240
    s_nop 0
    buffer_load_dwordx4 v2, s[76:79], s47 offen lds
    s_cmp_eq_u32 s28, 4
    s_mov_b32 s47, 35840
    s_cmov_b32 s47, 153600
    s_add_u32 s47, s47, s27
    s_add_u32 m0, s31, 11264
    s_nop 0
    buffer_load_dwordx4 v2, s[76:79], s47 offen lds
    s_add_u32 s27, s44, 192
    s_min_u32 s27, s27, 199
    s_mul_i32 s45, s27, 205
    s_lshr_b32 s45, s45, 11
    s_mul_i32 s28, s45, 10
    s_sub_u32 s47, s27, s28
    s_mov_b32 s60, s45
    s_mov_b32 s61, s47
    s_mul_i32 s27, s45, 205
    s_lshr_b32 s27, s27, 10
    s_mul_i32 s28, s27, 5
    s_sub_u32 s28, s45, s28
    s_mul_i32 s27, s27, 204800
    s_lshl_b32 s47, s47, 7
    s_add_u32 s27, s27, s47
    s_mul_i32 s47, s28, 51200
    s_cmp_eq_u32 s28, 4
    s_cselect_b32 s47, 0, s47
    s_cselect_b64 vcc, -1, 0
    s_add_u32 s27, s27, s47
    v_cndmask_b32 v2, v23, v24, vcc
    s_cmp_eq_u32 s28, 4
    s_mov_b32 s47, 0
    s_cmov_b32 s47, 0
    s_add_u32 s47, s47, s27
    s_add_u32 m0, s31, 12288
    s_nop 0
    buffer_load_dwordx4 v2, s[76:79], s47 offen lds
    s_cmp_eq_u32 s28, 4
    s_mov_b32 s47, 10240
    s_cmov_b32 s47, 51200
    s_add_u32 s47, s47, s27
    s_add_u32 m0, s31, 13312
    s_nop 0
    buffer_load_dwordx4 v2, s[76:79], s47 offen lds
    s_cmp_eq_u32 s28, 4
    s_mov_b32 s47, 25600
    s_cmov_b32 s47, 102400
    s_add_u32 s47, s47, s27
    s_add_u32 m0, s31, 14336
    s_nop 0
    buffer_load_dwordx4 v2, s[76:79], s47 offen lds
    s_cmp_eq_u32 s28, 4
    s_mov_b32 s47, 35840
    s_cmov_b32 s47, 153600
    s_add_u32 s47, s47, s27
    s_add_u32 m0, s31, 15360
    s_nop 0
    buffer_load_dwordx4 v2, s[76:79], s47 offen lds
    s_waitcnt vmcnt(12)
    ds_read_b64_tr_b16 v[32:33], v25 offset:0
    ds_read_b64_tr_b16 v[34:35], v25 offset:1024
    ds_read_b64_tr_b16 v[36:37], v25 offset:32
    ds_read_b64_tr_b16 v[38:39], v25 offset:1056
    ds_read_b64_tr_b16 v[40:41], v25 offset:64
    ds_read_b64_tr_b16 v[42:43], v25 offset:1088
    ds_read_b64_tr_b16 v[44:45], v25 offset:96
    ds_read_b64_tr_b16 v[46:47], v25 offset:1120
    s_lshl_b32 s27, s55, 2
    s_add_u32 s27, s27, 0
    s_mul_i32 s28, s27, 205
    s_lshr_b32 s28, s28, 10
    s_mul_i32 s28, s28, 95
    s_add_u32 s27, s27, s28
    s_mul_i32 s28, s54, 5
    s_add_u32 s27, s27, s28
    s_lshl_b32 s27, s27, 10
    s_waitcnt lgkmcnt(6)
    buffer_store_dwordx4 v[32:35], v6, s[40:43], s27 offen sc1
    s_lshl_b32 s27, s55, 2
    s_add_u32 s27, s27, 1
    s_mul_i32 s28, s27, 205
    s_lshr_b32 s28, s28, 10
    s_mul_i32 s28, s28, 95
    s_add_u32 s27, s27, s28
    s_mul_i32 s28, s54, 5
    s_add_u32 s27, s27, s28
    s_lshl_b32 s27, s27, 10
    s_waitcnt lgkmcnt(4)
    buffer_store_dwordx4 v[36:39], v6, s[40:43], s27 offen sc1
    s_lshl_b32 s27, s55, 2
    s_add_u32 s27, s27, 2
    s_mul_i32 s28, s27, 205
    s_lshr_b32 s28, s28, 10
    s_mul_i32 s28, s28, 95
    s_add_u32 s27, s27, s28
    s_mul_i32 s28, s54, 5
    s_add_u32 s27, s27, s28
    s_lshl_b32 s27, s27, 10
    s_waitcnt lgkmcnt(2)
    buffer_store_dwordx4 v[40:43], v6, s[40:43], s27 offen sc1
    s_lshl_b32 s27, s55, 2
    s_add_u32 s27, s27, 3
    s_mul_i32 s28, s27, 205
    s_lshr_b32 s28, s28, 10
    s_mul_i32 s28, s28, 95
    s_add_u32 s27, s27, s28
    s_mul_i32 s28, s54, 5
    s_add_u32 s27, s27, s28
    s_lshl_b32 s27, s27, 10
    s_waitcnt lgkmcnt(0)
    buffer_store_dwordx4 v[44:47], v6, s[40:43], s27 offen sc1
    s_waitcnt vmcnt(12)
    ds_read_b64_tr_b16 v[48:49], v25 offset:4096
    ds_read_b64_tr_b16 v[50:51], v25 offset:5120
    ds_read_b64_tr_b16 v[52:53], v25 offset:4128
    ds_read_b64_tr_b16 v[54:55], v25 offset:5152
    ds_read_b64_tr_b16 v[56:57], v25 offset:4160
    ds_read_b64_tr_b16 v[58:59], v25 offset:5184
    ds_read_b64_tr_b16 v[60:61], v25 offset:4192
    ds_read_b64_tr_b16 v[62:63], v25 offset:5216
    s_lshl_b32 s27, s57, 2
    s_add_u32 s27, s27, 0
    s_mul_i32 s28, s27, 205
    s_lshr_b32 s28, s28, 10
    s_mul_i32 s28, s28, 95
    s_add_u32 s27, s27, s28
    s_mul_i32 s28, s56, 5
    s_add_u32 s27, s27, s28
    s_lshl_b32 s27, s27, 10
    s_waitcnt lgkmcnt(6)
    buffer_store_dwordx4 v[48:51], v6, s[40:43], s27 offen sc1
    s_lshl_b32 s27, s57, 2
    s_add_u32 s27, s27, 1
    s_mul_i32 s28, s27, 205
    s_lshr_b32 s28, s28, 10
    s_mul_i32 s28, s28, 95
    s_add_u32 s27, s27, s28
    s_mul_i32 s28, s56, 5
    s_add_u32 s27, s27, s28
    s_lshl_b32 s27, s27, 10
    s_waitcnt lgkmcnt(4)
    buffer_store_dwordx4 v[52:55], v6, s[40:43], s27 offen sc1
    s_lshl_b32 s27, s57, 2
    s_add_u32 s27, s27, 2
    s_mul_i32 s28, s27, 205
    s_lshr_b32 s28, s28, 10
    s_mul_i32 s28, s28, 95
    s_add_u32 s27, s27, s28
    s_mul_i32 s28, s56, 5
    s_add_u32 s27, s27, s28
    s_lshl_b32 s27, s27, 10
    s_waitcnt lgkmcnt(2)
    buffer_store_dwordx4 v[56:59], v6, s[40:43], s27 offen sc1
    s_lshl_b32 s27, s57, 2
    s_add_u32 s27, s27, 3
    s_mul_i32 s28, s27, 205
    s_lshr_b32 s28, s28, 10
    s_mul_i32 s28, s28, 95
    s_add_u32 s27, s27, s28
    s_mul_i32 s28, s56, 5
    s_add_u32 s27, s27, s28
    s_lshl_b32 s27, s27, 10
    s_waitcnt lgkmcnt(0)
    buffer_store_dwordx4 v[60:63], v6, s[40:43], s27 offen sc1
    s_waitcnt vmcnt(12)
    ds_read_b64_tr_b16 v[64:65], v25 offset:8192
    ds_read_b64_tr_b16 v[66:67], v25 offset:9216
    ds_read_b64_tr_b16 v[68:69], v25 offset:8224
    ds_read_b64_tr_b16 v[70:71], v25 offset:9248
    ds_read_b64_tr_b16 v[72:73], v25 offset:8256
    ds_read_b64_tr_b16 v[74:75], v25 offset:9280
    ds_read_b64_tr_b16 v[76:77], v25 offset:8288
    ds_read_b64_tr_b16 v[78:79], v25 offset:9312
    s_lshl_b32 s27, s59, 2
    s_add_u32 s27, s27, 0
    s_mul_i32 s28, s27, 205
    s_lshr_b32 s28, s28, 10
    s_mul_i32 s28, s28, 95
    s_add_u32 s27, s27, s28
    s_mul_i32 s28, s58, 5
    s_add_u32 s27, s27, s28
    s_lshl_b32 s27, s27, 10
    s_waitcnt lgkmcnt(6)
    buffer_store_dwordx4 v[64:67], v6, s[40:43], s27 offen sc1
    s_lshl_b32 s27, s59, 2
    s_add_u32 s27, s27, 1
    s_mul_i32 s28, s27, 205
    s_lshr_b32 s28, s28, 10
    s_mul_i32 s28, s28, 95
    s_add_u32 s27, s27, s28
    s_mul_i32 s28, s58, 5
    s_add_u32 s27, s27, s28
    s_lshl_b32 s27, s27, 10
    s_waitcnt lgkmcnt(4)
    buffer_store_dwordx4 v[68:71], v6, s[40:43], s27 offen sc1
    s_lshl_b32 s27, s59, 2
    s_add_u32 s27, s27, 2
    s_mul_i32 s28, s27, 205
    s_lshr_b32 s28, s28, 10
    s_mul_i32 s28, s28, 95
    s_add_u32 s27, s27, s28
    s_mul_i32 s28, s58, 5
    s_add_u32 s27, s27, s28
    s_lshl_b32 s27, s27, 10
    s_waitcnt lgkmcnt(2)
    buffer_store_dwordx4 v[72:75], v6, s[40:43], s27 offen sc1
    s_lshl_b32 s27, s59, 2
    s_add_u32 s27, s27, 3
    s_mul_i32 s28, s27, 205
    s_lshr_b32 s28, s28, 10
    s_mul_i32 s28, s28, 95
    s_add_u32 s27, s27, s28
    s_mul_i32 s28, s58, 5
    s_add_u32 s27, s27, s28
    s_lshl_b32 s27, s27, 10
    s_waitcnt lgkmcnt(0)
    buffer_store_dwordx4 v[76:79], v6, s[40:43], s27 offen sc1
    s_waitcnt vmcnt(12)
    ds_read_b64_tr_b16 v[80:81], v25 offset:12288
    ds_read_b64_tr_b16 v[82:83], v25 offset:13312
    ds_read_b64_tr_b16 v[84:85], v25 offset:12320
    ds_read_b64_tr_b16 v[86:87], v25 offset:13344
    ds_read_b64_tr_b16 v[88:89], v25 offset:12352
    ds_read_b64_tr_b16 v[90:91], v25 offset:13376
    ds_read_b64_tr_b16 v[92:93], v25 offset:12384
    ds_read_b64_tr_b16 v[94:95], v25 offset:13408
    s_lshl_b32 s27, s61, 2
    s_add_u32 s27, s27, 0
    s_mul_i32 s28, s27, 205
    s_lshr_b32 s28, s28, 10
    s_mul_i32 s28, s28, 95
    s_add_u32 s27, s27, s28
    s_mul_i32 s28, s60, 5
    s_add_u32 s27, s27, s28
    s_lshl_b32 s27, s27, 10
    s_waitcnt lgkmcnt(6)
    buffer_store_dwordx4 v[80:83], v6, s[40:43], s27 offen sc1
    s_lshl_b32 s27, s61, 2
    s_add_u32 s27, s27, 1
    s_mul_i32 s28, s27, 205
    s_lshr_b32 s28, s28, 10
    s_mul_i32 s28, s28, 95
    s_add_u32 s27, s27, s28
    s_mul_i32 s28, s60, 5
    s_add_u32 s27, s27, s28
    s_lshl_b32 s27, s27, 10
    s_waitcnt lgkmcnt(4)
    buffer_store_dwordx4 v[84:87], v6, s[40:43], s27 offen sc1
    s_lshl_b32 s27, s61, 2
    s_add_u32 s27, s27, 2
    s_mul_i32 s28, s27, 205
    s_lshr_b32 s28, s28, 10
    s_mul_i32 s28, s28, 95
    s_add_u32 s27, s27, s28
    s_mul_i32 s28, s60, 5
    s_add_u32 s27, s27, s28
    s_lshl_b32 s27, s27, 10
    s_waitcnt lgkmcnt(2)
    buffer_store_dwordx4 v[88:91], v6, s[40:43], s27 offen sc1
    s_lshl_b32 s27, s61, 2
    s_add_u32 s27, s27, 3
    s_mul_i32 s28, s27, 205
    s_lshr_b32 s28, s28, 10
    s_mul_i32 s28, s28, 95
    s_add_u32 s27, s27, s28
    s_mul_i32 s28, s60, 5
    s_add_u32 s27, s27, s28
    s_lshl_b32 s27, s27, 10
    s_waitcnt lgkmcnt(0)
    buffer_store_dwordx4 v[92:95], v6, s[40:43], s27 offen sc1
    s_lshl_b32 s3, s25, 11
    s_add_u32 s3, s3, 92032
    s_mov_b32 s91, 0x40000
L_k1_sz:
    s_sleep 8
    buffer_load_dword v2, v8, s[64:67], 0 offen offset:128 sc1
    s_sub_u32 s91, s91, 1
    s_cmp_eq_u32 s91, 0
    s_cbranch_scc1 L_k1_sz2
    s_waitcnt vmcnt(0)
    v_readfirstlane_b32 s27, v2
    s_nop 1
    s_cmp_lt_u32 s27, 64
    s_cbranch_scc1 L_k1_sz
L_k1_sz2:
    s_waitcnt vmcnt(0)
    s_mov_b32 s27, 124928
    s_mov_b64 exec, 1
    buffer_atomic_add v9, v8, s[72:75], s27 offen sc1
    s_mov_b64 exec, -1
    s_barrier
    s_branch L_p2_start
L_k1_eps_m:
    s_mov_b32 s91, 0x40000
L_k1_eps1_m:
    s_sleep 8
    buffer_load_dword v10, v8, s[64:67], 0 offen sc1
    s_waitcnt vmcnt(0)
    v_readfirstlane_b32 s51, v10
    s_sub_u32 s91, s91, 1
    s_cmp_eq_u32 s91, 0
    s_cbranch_scc1 L_k1_epok_m
    s_cmp_eq_u32 s51, 0
    s_cbranch_scc1 L_k1_eps1_m
    s_branch L_k1_epok_m
L_k1_eps_s:
    s_mov_b32 s91, 0x40000
L_k1_eps1_s:
    s_sleep 8
    buffer_load_dword v10, v8, s[64:67], 0 offen sc1
    s_waitcnt vmcnt(0)
    v_readfirstlane_b32 s51, v10
    s_sub_u32 s91, s91, 1
    s_cmp_eq_u32 s91, 0
    s_cbranch_scc1 L_k1_epok_s
    s_cmp_eq_u32 s51, 0
    s_cbranch_scc1 L_k1_eps1_s
    s_branch L_k1_epok_s
L_p2_start:
    s_load_dwordx2 s[18:19], s[0:1], 56
    v_lshrrev_b32 v2, 6, v0
    v_and_b32 v1, 63, v0
    v_readfirstlane_b32 s24, v2
    s_lshr_b32 s63, s2, 5
    s_and_b32 s96, s2, 7
    s_lshl_b32 s96, s96, 2
    s_bfe_u32 s27, s2, 0x20003
    s_add_u32 s96, s96, s27
    v_and_b32 v18, 31, v1
    v_lshrrev_b32 v19, 5, v1
    s_mul_i32 s97, s96, 5
    s_lshr_b32 s97, s97, 2
    s_and_b32 s98, s96, 3
    v_lshlrev_b32 v3, 2, v19
    v_xor_b32 v3, v3, v18
    v_lshlrev_b32 v3, 4, v3
    v_lshl_add_u32 v12, v19, 9, v3
    v_xor_b32 v13, 0x80, v12
    s_lshl_b32 s27, s63, 3
    s_lshl_b32 s28, s24, 2
    s_add_u32 s27, s27, s28
    s_sub_i32 s27, s27, 8
    s_max_i32 s27, s27, 0
    s_mul_i32 s27, s27, 120
    s_add_u32 s27, s27, s97
    s_add_u32 s27, s27, 40
    s_lshl_b32 s6, s27, 10
    s_lshl_b32 s7, s24, 13
    s_lshl_b32 s99, s63, 3
    s_lshl_b32 s28, s24, 1
    s_add_u32 s99, s99, s28
    s_sub_u32 s17, 8, s99
    s_mul_i32 s21, s99, 120
    s_add_u32 s21, s21, s97
    s_lshl_b32 s21, s21, 10
    s_lshl_b32 s27, s63, 1
    s_add_u32 s27, s27, s24
    s_sub_i32 s27, s27, 2
    s_max_i32 s27, s27, 0
    s_lshr_b32 s28, s99, 2
    v_mov_b32 v2, s27
    v_mov_b32 v3, s28
    v_cmp_gt_u32 vcc, 2, v1
    v_and_b32 v4, 1, v1
    v_add_u32 v4, s97, v4
    v_cndmask_b32 v2, v2, v3, vcc
    v_lshrrev_b32 v4, 3, v4
    v_lshl_add_u32 v2, v2, 4, v4
    v_lshrrev_b32 v3, 1, v1
    v_mul_u32_u24 v3, 5, v3
    v_add_u32 v2, v2, v3
    v_lshlrev_b32 v2, 7, v2
    v_add_u32 v239, 0x16000, v2
    v_subrev_u32 v2, s98, v19
    v_lshlrev_b32 v6, 4, v1
    v_mov_b32 v4, 0x7fffffff
    v_add_u32 v5, 0, v2
    v_cmp_gt_u32 vcc, 5, v5
    s_nop 1
    v_cndmask_b32 v224, v4, v6, vcc
    v_add_u32 v5, 2, v2
    v_cmp_gt_u32 vcc, 5, v5
    s_nop 1
    v_cndmask_b32 v225, v4, v6, vcc
    v_add_u32 v5, 4, v2
    v_cmp_gt_u32 vcc, 5, v5
    s_nop 1
    v_cndmask_b32 v226, v4, v6, vcc
    v_add_u32 v5, 6, v2
    v_cmp_gt_u32 vcc, 5, v5
    s_nop 1
    v_cndmask_b32 v227, v4, v6, vcc
    v_mov_b32 v5, 0x3f803f80
    v_accvgpr_write_b32 a244, v5
    v_accvgpr_write_b32 a245, v5
    v_accvgpr_write_b32 a246, v5
    v_accvgpr_write_b32 a247, v5
    v_cmp_gt_u32 vcc, 32, v1
    v_mov_b32 v5, 0xf149
    s_nop 0
    v_cndmask_b32 v5, 0, v5, vcc
    v_accvgpr_write_b32 a248, v5
    v_accvgpr_write_b32 a249, 0
    v_accvgpr_write_b32 a250, 0
    v_accvgpr_write_b32 a251, 0
    v_lshlrev_b32 v2, 2, v19
    v_sub_u32 v2, v18, v2
    v_mov_b32 v3, 0xffff
    v_mov_b32 v4, 0xffff0000
    v_cmp_gt_i32 s[64:65], 0, v2
    v_cmp_gt_i32 s[66:67], 1, v2
    v_cmp_gt_i32 s[68:69], 2, v2
    v_cmp_gt_i32 s[70:71], 3, v2
    v_cmp_gt_i32 s[72:73], 8, v2
    v_cmp_gt_i32 s[74:75], 9, v2
    v_cmp_gt_i32 s[76:77], 10, v2
    v_cmp_gt_i32 s[78:79], 11, v2
    v_cmp_gt_i32 s[80:81], 16, v2
    v_cmp_gt_i32 s[82:83], 17, v2
    v_cmp_gt_i32 s[84:85], 18, v2
    v_cmp_gt_i32 s[86:87], 19, v2
    v_cmp_gt_i32 s[88:89], 24, v2
    v_cmp_gt_i32 s[90:91], 25, v2
    v_cmp_gt_i32 s[92:93], 26, v2
    v_cmp_gt_i32 s[94:95], 27, v2
    v_cndmask_b32 v216, 0, v3, s[64:65]
    v_cndmask_b32 v5, 0, v4, s[66:67]
    v_or_b32 v216, v216, v5
    v_cndmask_b32 v217, 0, v3, s[68:69]
    v_cndmask_b32 v5, 0, v4, s[70:71]
    v_or_b32 v217, v217, v5
    v_cndmask_b32 v218, 0, v3, s[72:73]
    v_cndmask_b32 v5, 0, v4, s[74:75]
    v_or_b32 v218, v218, v5
    v_cndmask_b32 v219, 0, v3, s[76:77]
    v_cndmask_b32 v5, 0, v4, s[78:79]
    v_or_b32 v219, v219, v5
    v_cndmask_b32 v220, 0, v3, s[80:81]
    v_cndmask_b32 v5, 0, v4, s[82:83]
    v_or_b32 v220, v220, v5
    v_cndmask_b32 v221, 0, v3, s[84:85]
    v_cndmask_b32 v5, 0, v4, s[86:87]
    v_or_b32 v221, v221, v5
    v_cndmask_b32 v222, 0, v3, s[88:89]
    v_cndmask_b32 v5, 0, v4, s[90:91]
    v_or_b32 v222, v222, v5
    v_cndmask_b32 v223, 0, v3, s[92:93]
    v_cndmask_b32 v5, 0, v4, s[94:95]
    v_or_b32 v223, v223, v5
    s_add_u32 s27, s98, 5
    s_and_b32 s27, s27, 7
    s_lshr_b32 s28, s27, 2
    s_lshl_b32 s28, s28, 10
    s_and_b32 s62, s27, 1
    s_lshl_b32 s62, s62, 9
    s_add_u32 s28, s28, s62
    s_and_b32 s62, s27, 2
    s_lshl_b32 s62, s62, 2
    s_add_u32 s28, s28, s62
    s_add_u32 s28, s28, s7
    v_lshlrev_b32 v2, 4, v18
    v_lshl_add_u32 v2, v19, 11, v2
    v_add_u32 v238, s28, v2
    s_lshl_b32 s28, s24, 12
    v_bfe_u32 v3, v1, 4, 1
    v_and_b32 v4, 3, v1
    v_lshl_add_u32 v3, v3, 2, v4
    v_min_u32 v3, 5, v3
    v_add_u32 v3, s98, v3
    v_bfe_u32 v4, v3, 2, 1
    v_and_b32 v5, 1, v3
    v_lshl_add_u32 v4, v4, 1, v5
    v_xor_b32 v5, v4, v19
    v_lshlrev_b32 v5, 6, v5
    v_bfe_u32 v14, v1, 2, 2
    v_lshl_add_u32 v5, v14, 4, v5
    v_bfe_u32 v3, v3, 1, 1
    v_lshl_add_u32 v5, v3, 3, v5
    v_lshlrev_b32 v4, 9, v4
    s_add_u32 s27, s28, 32768
    v_add_u32 v4, s27, v4
    v_add_u32 v14, v4, v5
    v_xor_b32 v5, 0x80, v5
    v_add_u32 v15, v4, v5
    s_mul_i32 s27, s99, 40960
    s_lshl_b32 s28, s96, 10
    s_add_u32 s28, s28, s27
    v_add_u32 v16, s28, v6
    s_lshl_b32 s28, s96, 8
    s_add_u32 s28, s28, s27
    s_add_u32 s28, s28, 32768
    v_lshlrev_b32 v2, 3, v18
    v_add_u32 v17, s28, v2
    v_lshl_add_u32 v17, v19, 30, v17
    s_lshl_b32 s27, s99, 2
    s_lshr_b32 s28, s96, 3
    s_add_u32 s27, s27, s28
    s_lshl_b32 s27, s27, 7
    s_add_u32 s20, s27, 57344
    v_mov_b32 v22, 0
    v_mov_b32 v23, 0
    s_add_u32 s8, s22, 0x1c00000
    s_addc_u32 s9, s23, 0
    s_mov_b32 s10, 0x20000
    s_mov_b32 s11, 0x00020000
    v_mov_b32 v250, 0x1e800
    buffer_load_dword v251, v250, s[8:11], 0 offen sc1
    s_waitcnt vmcnt(1) lgkmcnt(0)
    s_mov_b64 exec, 1
    buffer_atomic_add v9, v8, s[8:11], s3 offen sc1
    s_mov_b64 exec, -1
    s_lshr_b32 s28, s2, 3
    s_and_b32 s25, s2, 7
    s_lshl_b32 s25, s25, 2
    s_and_b32 s27, s28, 3
    s_add_u32 s25, s25, s27
    s_lshr_b32 s26, s28, 2
    v_and_b32 v2, 15, v1
    v_lshrrev_b32 v3, 4, v1
    v_lshlrev_b32 v240, 4, v2
    v_lshl_add_u32 v240, v3, 9, v240
    s_and_b32 s27, s24, 1
    s_lshl_b32 s28, s27, 8
    v_add_u32 v240, s28, v240
    v_xor_b32 v241, 0x100, v240
    v_add_u32 v7, 0x1000, v6
    s_lshl_b32 s63, s25, 1
    s_lshr_b32 s28, s24, 1
    s_add_u32 s63, s63, s28
    s_xor_b32 s28, s63, 1
    s_mul_i32 s56, s63, 40960
    s_mul_i32 s57, s28, 40960
    s_mul_i32 s27, s24, 8192
    s_add_u32 s56, s56, s27
    s_add_u32 s57, s57, s27
    s_lshl_b32 s27, s26, 2
    s_add_u32 s27, s27, s24
    s_mul_i32 s30, s27, 25600
    s_mul_i32 s58, s27, 61440
    s_mul_i32 s29, s24, 15360
    v_lshrrev_b32 v4, 1, v3
    v_and_b32 v5, 1, v3
    v_lshl_add_u32 v4, v4, 2, v5
    v_lshlrev_b32 v4, 8, v4
    v_lshl_add_u32 v4, v2, 3, v4
    s_mul_i32 s27, s24, -6144
    s_add_u32 s27, s27, 32768
    s_and_b32 s28, s24, 1
    s_lshl_b32 s28, s28, 7
    s_add_u32 s27, s27, s28
    v_add_u32 v248, s27, v4
    v_xor_b32 v249, 0x80, v248
    s_lshl_b32 s27, s25, 6
    s_lshl_b32 s28, s24, 4
    s_add_u32 s27, s27, s28
    v_add_u32 v4, s27, v2
    v_mul_u32_u24 v5, 1280, v4
    v_lshl_add_u32 v5, v3, 3, v5
    s_mul_i32 s27, s26, 160
    v_add_u32 v242, s27, v5
    s_mul_i32 s27, s63, 40
    s_mul_i32 s28, s26, 5
    s_add_u32 s27, s27, s28
    s_lshl_b32 s27, s27, 10
    s_and_b32 s28, s24, 1
    s_lshl_b32 s28, s28, 8
    s_add_u32 s27, s27, s28
    v_and_b32 v5, 1, v3
    v_lshlrev_b32 v5, 9, v5
    v_lshl_add_u32 v5, v2, 4, v5
    v_lshrrev_b32 v243, 1, v3
    v_lshl_add_u32 v5, v243, 3, v5
    v_add_u32 v243, s27, v5
    s_movk_i32 s55, 0x1000
    s_mov_b32 s52, 0xffff0000
    s_mov_b32 s61, 0x07060302
    v_mov_b32 v8, 0
    v_mov_b32 v9, 1
    v_add_u32 v244, s29, v6
    s_xor_b32 s27, s24, 1
    s_mul_i32 s27, s27, 15360
    v_add_u32 v245, s27, v6
    s_xor_b32 s27, s24, 2
    s_mul_i32 s27, s27, 15360
    v_add_u32 v246, s27, v6
    s_xor_b32 s27, s24, 3
    s_mul_i32 s27, s27, 15360
    v_add_u32 v247, s27, v6
    s_and_b32 s27, s2, 7
    s_lshr_b32 s28, s2, 3
    s_lshr_b32 s31, s27, 1
    s_lshl_b32 s31, s31, 2
    s_and_b32 s53, s27, 1
    s_lshl_b32 s53, s53, 3
    s_and_b32 s27, s28, 3
    s_lshr_b32 s28, s28, 2
    s_add_u32 s31, s31, s27
    s_add_u32 s53, s53, s28
    s_mul_i32 s59, s24, 5120
    s_mul_i32 s60, s53, 245760
    s_add_u32 s16, s60, s59
    s_add_u32 s59, s59, 61440
    s_lshl_b32 s54, s31, 2
    s_add_u32 s54, s54, s24
    s_mul_i32 s60, s54, 40960
    s_add_u32 s36, s22, 0x1500000
    s_addc_u32 s37, s23, 0
    s_mov_b32 s38, 0xc8000
    s_mov_b32 s39, 0x00020000
    s_mov_b32 s40, s4
    s_mov_b32 s41, s5
    s_mov_b32 s42, 0x280000
    s_mov_b32 s43, 0x00020000
    s_add_u32 s48, s22, 0x1400000
    s_addc_u32 s49, s23, 0
    s_mov_b32 s50, 0x20000
    s_mov_b32 s51, 0x00020000
    s_add_u32 s8, s22, 0x1c00000
    s_addc_u32 s9, s23, 0
    s_mov_b32 s10, 0x20000
    s_mov_b32 s11, 0x00020000
    s_add_u32 s12, s22, 0x1600000
    s_addc_u32 s13, s23, 0
    s_mov_b32 s14, 0x3c0000
    s_mov_b32 s15, 0x00020000
    s_waitcnt vmcnt(1)
    v_cmp_gt_u32 vcc, 64, v251
    s_nop 1
    s_cmp_lg_u64 vcc, 0
    s_cbranch_scc1 L_cw_slow
L_cw_ok:
    buffer_load_dwordx4 a[80:83], v6, s[36:39], s30 offen offset:0 sc1
    buffer_load_dwordx4 a[84:87], v6, s[36:39], s30 offen offset:1024 sc1
    buffer_load_dwordx4 a[88:91], v6, s[36:39], s30 offen offset:2048 sc1
    buffer_load_dwordx4 a[92:95], v6, s[36:39], s30 offen offset:3072 sc1
    buffer_load_dwordx4 a[96:99], v7, s[36:39], s30 offen sc1
    s_add_u32 s30, s30, 5120
    buffer_load_dwordx4 a[100:103], v6, s[36:39], s30 offen offset:0 sc1
    buffer_load_dwordx4 a[104:107], v6, s[36:39], s30 offen offset:1024 sc1
    buffer_load_dwordx4 a[108:111], v6, s[36:39], s30 offen offset:2048 sc1
    buffer_load_dwordx4 a[112:115], v6, s[36:39], s30 offen offset:3072 sc1
    buffer_load_dwordx4 a[116:119], v7, s[36:39], s30 offen sc1
    s_add_u32 s30, s30, 5120
    s_mov_b64 exec, 0x3f
    s_mov_b32 s62, 0x40000
L_poll_p2:
    v_mov_b32 v2, 0
    buffer_atomic_add v2, v239, s[8:11], 0 offen sc0 sc1
    s_sub_u32 s62, s62, 1
    s_cmp_eq_u32 s62, 0
    s_cbranch_scc1 L_polled_p2
    s_waitcnt vmcnt(0)
    v_cmp_gt_u32 vcc, 4, v2
    s_nop 1
    s_cmp_lg_u64 vcc, 0
    s_cbranch_scc1 L_poll_p2
L_polled_p2:
    s_waitcnt vmcnt(0)
    s_mov_b64 exec, -1
    s_mov_b32 s32, s22
    s_mov_b32 s33, s23
    s_mov_b32 s34, 0x780000
    s_mov_b32 s35, 0x00020000
    s_add_u32 m0, s7, 0
    s_add_u32 s3, s6, 0
    s_add_u32 s97, s3, 120832
    buffer_load_dwordx4 v12, s[32:35], s3 offen sc1 lds
    buffer_load_dwordx4 v13, s[32:35], s3 offen offset:1024 sc1 lds
    buffer_load_dwordx4 v12, s[32:35], s97 offen offset:2048 sc1 lds
    buffer_load_dwordx4 v13, s[32:35], s97 offen offset:3072 sc1 lds
    s_add_u32 m0, s7, 4096
    s_add_u32 s3, s6, 245760
    s_add_u32 s97, s3, 120832
    buffer_load_dwordx4 v12, s[32:35], s3 offen sc1 lds
    buffer_load_dwordx4 v13, s[32:35], s3 offen offset:1024 sc1 lds
    buffer_load_dwordx4 v12, s[32:35], s97 offen offset:2048 sc1 lds
    buffer_load_dwordx4 v13, s[32:35], s97 offen offset:3072 sc1 lds
    buffer_load_dwordx2 a[180:181], v224, s[32:35], s21 offen offset:0 sc1
    buffer_load_dwordx2 a[182:183], v225, s[32:35], s21 offen offset:8 sc1
    buffer_load_dwordx2 a[184:185], v226, s[32:35], s21 offen offset:1024 sc1
    buffer_load_dwordx2 a[186:187], v227, s[32:35], s21 offen offset:1032 sc1
    s_add_u32 s44, s22, 0x800000
    s_addc_u32 s45, s23, 0
    s_mov_b32 s46, 0x280000
    s_mov_b32 s47, 0x00020000
    s_add_u32 m0, s7, 32768
    s_add_u32 s3, s6, 40960
    s_add_u32 s97, s3, 120832
    buffer_load_dwordx4 v12, s[32:35], s3 offen sc1 lds
    buffer_load_dwordx4 v13, s[32:35], s3 offen offset:1024 sc1 lds
    buffer_load_dwordx4 v12, s[32:35], s97 offen offset:2048 sc1 lds
    buffer_load_dwordx4 v13, s[32:35], s97 offen offset:3072 sc1 lds
    s_add_u32 m0, s7, 36864
    s_add_u32 s3, s6, 286720
    s_add_u32 s97, s3, 120832
    buffer_load_dwordx4 v12, s[32:35], s3 offen sc1 lds
    buffer_load_dwordx4 v13, s[32:35], s3 offen offset:1024 sc1 lds
    buffer_load_dwordx4 v12, s[32:35], s97 offen offset:2048 sc1 lds
    buffer_load_dwordx4 v13, s[32:35], s97 offen offset:3072 sc1 lds
    s_add_u32 s21, s21, 122880
    buffer_load_dwordx2 a[188:189], v224, s[32:35], s21 offen offset:0 sc1
    buffer_load_dwordx2 a[190:191], v225, s[32:35], s21 offen offset:8 sc1
    buffer_load_dwordx2 a[192:193], v226, s[32:35], s21 offen offset:1024 sc1
    buffer_load_dwordx2 a[194:195], v227, s[32:35], s21 offen offset:1032 sc1
    s_add_u32 s32, s22, 0x800000
    s_addc_u32 s33, s23, 0
    s_mov_b32 s34, 0x280000
    s_mov_b32 s35, 0x00020000
    v_mov_b32 v226, 0x3f803f80
    v_mov_b32 v227, 0x3f803f80
    v_mov_b32 v224, v238
    s_lshl_b32 s62, s24, 12
    v_add_u32 v12, s62, v12
    v_add_u32 v13, s62, v13
    s_mov_b32 s21, 40960
    s_waitcnt vmcnt(12)
    s_barrier
    v_and_b32 v250, 15, v1
    v_lshlrev_b32 v250, 7, v250
    v_add_u32 v250, 0x1e000, v250
    ds_read_b128 a[196:199], v12 offset:0
    ds_read_b128 a[200:203], v13 offset:1024
    ds_read_b128 a[204:207], v12 offset:16384
    ds_read_b128 a[208:211], v13 offset:17408
    ds_read_b128 a[212:215], v12 offset:2048
    ds_read_b128 a[216:219], v13 offset:3072
    s_waitcnt lgkmcnt(4)
    v_mfma_f32_32x32x16_bf16 v[40:55], a[196:199], a[180:183], 0
    v_mfma_f32_32x32x16_bf16 v[40:55], a[200:203], a[184:187], v[40:55]
    s_cmp_gt_i32 s17, 0
    s_cbranch_scc1 L_inv_1
L_inv_1r:
    ds_read_b128 a[196:199], v12 offset:4096
    ds_read_b128 a[200:203], v13 offset:5120
    s_waitcnt lgkmcnt(4)
    v_mfma_f32_32x32x16_bf16 v[56:71], a[204:207], a[180:183], 0
    v_mfma_f32_32x32x16_bf16 v[56:71], a[208:211], a[184:187], v[56:71]
    ds_read_b128 a[204:207], v12 offset:6144
    ds_read_b128 a[208:211], v13 offset:7168
    s_waitcnt lgkmcnt(4)
    v_mfma_f32_32x32x16_bf16 v[72:87], a[212:215], a[180:183], 0
    v_mfma_f32_32x32x16_bf16 v[72:87], a[216:219], a[184:187], v[72:87]
    s_cmp_gt_i32 s17, 1
    s_cbranch_scc1 L_inv_2
L_inv_2r:
    ds_read_b128 a[212:215], v12 offset:8192
    ds_read_b128 a[216:219], v13 offset:9216
    s_waitcnt lgkmcnt(4)
    v_mfma_f32_32x32x16_bf16 v[88:103], a[196:199], a[180:183], 0
    s_nop 0
    v_cndmask_b32 v40, v56, v40, s[64:65]
    v_cndmask_b32 v41, v57, v41, s[66:67]
    v_cndmask_b32 v42, v58, v42, s[68:69]
    v_cndmask_b32 v43, v59, v43, s[70:71]
    v_cndmask_b32 v44, v60, v44, s[72:73]
    v_mfma_f32_32x32x16_bf16 v[88:103], a[200:203], a[184:187], v[88:103]
    v_cndmask_b32 v45, v61, v45, s[74:75]
    v_cndmask_b32 v46, v62, v46, s[76:77]
    v_cndmask_b32 v47, v63, v47, s[78:79]
    v_cndmask_b32 v48, v64, v48, s[80:81]
    v_cndmask_b32 v49, v65, v49, s[82:83]
    s_cmp_gt_i32 s17, 2
    s_cbranch_scc1 L_inv_3
L_inv_3r:
    ds_read_b128 a[196:199], v12 offset:10240
    ds_read_b128 a[200:203], v13 offset:11264
    s_waitcnt lgkmcnt(4)
    v_mfma_f32_32x32x16_bf16 v[104:119], a[204:207], a[180:183], 0
    v_cndmask_b32 v50, v66, v50, s[84:85]
    v_cndmask_b32 v51, v67, v51, s[86:87]
    v_cndmask_b32 v52, v68, v52, s[88:89]
    v_cndmask_b32 v53, v69, v53, s[90:91]
    v_cndmask_b32 v54, v70, v54, s[92:93]
    v_mfma_f32_32x32x16_bf16 v[104:119], a[208:211], a[184:187], v[104:119]
    v_cndmask_b32 v55, v71, v55, s[94:95]
    v_max3_f32 v10, v40, v41, v42
    v_max3_f32 v11, v43, v44, v45
    v_max3_f32 v10, v46, v47, v10
    v_max3_f32 v11, v48, v49, v11
    s_cmp_gt_i32 s17, 3
    s_cbranch_scc1 L_inv_4
L_inv_4r:
    ds_read_b128 a[204:207], v12 offset:12288
    ds_read_b128 a[208:211], v13 offset:13312
    s_waitcnt lgkmcnt(4)
    v_mfma_f32_32x32x16_bf16 v[120:135], a[212:215], a[180:183], 0
    v_max3_f32 v10, v50, v51, v10
    v_max3_f32 v11, v52, v53, v11
    v_max3_f32 v10, v54, v55, v10
    v_max3_f32 v10, v72, v73, v10
    v_max3_f32 v11, v74, v75, v11
    v_mfma_f32_32x32x16_bf16 v[120:135], a[216:219], a[184:187], v[120:135]
    v_max3_f32 v10, v76, v77, v10
    v_max3_f32 v11, v78, v79, v11
    v_max3_f32 v10, v80, v81, v10
    v_max3_f32 v11, v82, v83, v11
    v_max3_f32 v10, v84, v85, v10
    s_cmp_gt_i32 s17, 4
    s_cbranch_scc1 L_inv_5
L_inv_5r:
    ds_read_b128 a[212:215], v12 offset:14336
    ds_read_b128 a[216:219], v13 offset:15360
    s_waitcnt lgkmcnt(4)
    v_mfma_f32_32x32x16_bf16 v[136:151], a[196:199], a[180:183], 0
    v_max3_f32 v11, v86, v87, v11
    v_max3_f32 v10, v88, v89, v10
    v_max3_f32 v11, v90, v91, v11
    v_max3_f32 v10, v92, v93, v10
    v_max3_f32 v11, v94, v95, v11
    v_mfma_f32_32x32x16_bf16 v[136:151], a[200:203], a[184:187], v[136:151]
    v_max3_f32 v10, v96, v97, v10
    v_max3_f32 v11, v98, v99, v11
    v_max3_f32 v10, v100, v101, v10
    v_max3_f32 v11, v102, v103, v11
    v_max3_f32 v10, v104, v105, v10
    s_cmp_gt_i32 s17, 5
    s_cbranch_scc1 L_inv_6
L_inv_6r:
    s_waitcnt lgkmcnt(2)
    v_mfma_f32_32x32x16_bf16 v[152:167], a[204:207], a[180:183], 0
    v_max3_f32 v11, v106, v107, v11
    v_max3_f32 v10, v108, v109, v10
    v_max3_f32 v11, v110, v111, v11
    v_max3_f32 v10, v112, v113, v10
    v_max3_f32 v11, v114, v115, v11
    v_mfma_f32_32x32x16_bf16 v[152:167], a[208:211], a[184:187], v[152:167]
    v_max3_f32 v10, v116, v117, v10
    v_max3_f32 v11, v118, v119, v11
    v_max3_f32 v10, v120, v121, v10
    v_max3_f32 v11, v122, v123, v11
    v_max3_f32 v10, v124, v125, v10
    s_cmp_gt_i32 s17, 6
    s_cbranch_scc1 L_inv_7
L_inv_7r:
    s_waitcnt lgkmcnt(0)
    v_mfma_f32_32x32x16_bf16 v[168:183], a[212:215], a[180:183], 0
    v_max3_f32 v11, v126, v127, v11
    v_max3_f32 v10, v128, v129, v10
    v_max3_f32 v11, v130, v131, v11
    v_max3_f32 v10, v132, v133, v10
    v_max3_f32 v11, v134, v135, v11
    v_mfma_f32_32x32x16_bf16 v[168:183], a[216:219], a[184:187], v[168:183]
    v_max3_f32 v10, v136, v137, v10
    v_max3_f32 v11, v138, v139, v11
    v_max3_f32 v10, v140, v141, v10
    v_max3_f32 v11, v142, v143, v11
    v_max3_f32 v10, v144, v145, v10
    s_cmp_gt_i32 s17, 7
    s_cbranch_scc1 L_inv_8
L_inv_8r:
    v_max3_f32 v11, v146, v147, v11
    v_max3_f32 v10, v148, v149, v10
    v_max3_f32 v11, v150, v151, v11
    s_waitcnt vmcnt(0)
    ds_write_b64 v224, v[226:227] offset:32768
    ds_write_b64 v224, v[226:227] offset:36864
    v_max3_f32 v10, v152, v153, v10
    v_max3_f32 v11, v154, v155, v11
    v_max3_f32 v10, v156, v157, v10
    v_max3_f32 v11, v158, v159, v11
    v_max3_f32 v10, v160, v161, v10
    v_max3_f32 v11, v162, v163, v11
    v_max3_f32 v10, v164, v165, v10
    v_max3_f32 v11, v166, v167, v11
    s_waitcnt lgkmcnt(0)
    s_barrier
    ds_read_b64_tr_b16 a[220:221], v14 offset:0
    ds_read_b64_tr_b16 a[222:223], v15 offset:0
    ds_read_b64_tr_b16 a[224:225], v14 offset:256
    ds_read_b64_tr_b16 a[226:227], v15 offset:256
    ds_read_b64_tr_b16 a[228:229], v14 offset:16384
    ds_read_b64_tr_b16 a[230:231], v15 offset:16384
    ds_read_b64_tr_b16 a[232:233], v14 offset:16640
    ds_read_b64_tr_b16 a[234:235], v15 offset:16640
    ds_read_b128 a[196:199], v12 offset:2048
    ds_read_b128 a[200:203], v13 offset:3072
    ds_read_b128 a[204:207], v12 offset:18432
    ds_read_b128 a[208:211], v13 offset:19456
    v_max3_f32 v10, v168, v169, v10
    v_max3_f32 v11, v170, v171, v11
    v_max3_f32 v10, v172, v173, v10
    v_max3_f32 v11, v174, v175, v11
    v_max3_f32 v10, v176, v177, v10
    v_max3_f32 v11, v178, v179, v11
    v_max3_f32 v10, v180, v181, v10
    v_max3_f32 v11, v182, v183, v11
    v_max_f32 v10, v10, v11
    v_mov_b32 v11, v10
    v_cmp_gt_u32 vcc, 32, v1
    s_nop 0
    v_permlane32_swap_b32 v10, v11
    v_max_f32 v10, v10, v11
    v_cndmask_b32 v10, 0, -v10, vcc
    v_and_b32 v2, 0xffff0000, v10
    v_sub_f32 v2, v10, v2
    v_and_b32 v3, 0xffff0000, v2
    v_sub_f32 v3, v2, v3
    v_perm_b32 v20, v2, v10, s61
    v_lshrrev_b32 v21, 16, v3
    s_nop 1
    v_mfma_f32_32x32x16_bf16 v[40:55], a[244:247], v[20:23], v[40:55]
    v_mfma_f32_32x32x16_bf16 v[72:87], a[244:247], v[20:23], v[72:87]
    s_nop 10
    v_exp_f32 v40, v40
    buffer_load_dwordx4 a[120:123], v6, s[36:39], s30 offen offset:0 sc1
    v_exp_f32 v41, v41
    v_mfma_f32_32x32x16_bf16 v[88:103], a[244:247], v[20:23], v[88:103]
    buffer_load_dwordx4 a[124:127], v6, s[36:39], s30 offen offset:1024 sc1
    v_exp_f32 v42, v42
    v_exp_f32 v43, v43
    v_cvt_pk_bf16_f32 v40, v40, v41
    v_exp_f32 v44, v44
    s_waitcnt lgkmcnt(2)
    v_mfma_f32_32x32x16_bf16 v[184:199], a[196:199], a[188:191], 0
    v_exp_f32 v45, v45
    v_cvt_pk_bf16_f32 v41, v42, v43
    v_exp_f32 v46, v46
    v_exp_f32 v47, v47
    v_mfma_f32_32x32x16_bf16 v[184:199], a[200:203], a[192:195], v[184:199]
    s_cmp_gt_i32 s17, 1
    s_cbranch_scc1 L_inv_9
L_inv_9r:
    ds_read_b128 a[212:215], v12 offset:4096
    ds_read_b128 a[216:219], v13 offset:5120
    v_cvt_pk_bf16_f32 v42, v44, v45
    v_cvt_pk_bf16_f32 v43, v46, v47
    v_and_b32 v44, v216, v40
    v_and_b32 v45, v217, v41
    v_and_b32 v46, v218, v42
    v_and_b32 v47, v219, v43
    v_xor_b32 v40, v44, v40
    v_xor_b32 v41, v45, v41
    v_xor_b32 v42, v46, v42
    v_xor_b32 v43, v47, v43
    v_exp_f32 v48, v48
    s_waitcnt lgkmcnt(6)
    v_mfma_f32_32x32x16_bf16 v[24:39], a[220:223], v[44:47], 0
    ds_read_b64_tr_b16 a[236:237], v14 offset:2048
    v_exp_f32 v49, v49
    ds_read_b64_tr_b16 a[238:239], v15 offset:2048
    v_exp_f32 v50, v50
    ds_read_b64_tr_b16 a[240:241], v14 offset:2304
    v_exp_f32 v51, v51
    v_mfma_f32_32x32x16_bf16 v[24:39], a[228:231], v[40:43], v[24:39]
    ds_read_b64_tr_b16 a[242:243], v15 offset:2304
    v_cvt_pk_bf16_f32 v48, v48, v49
    v_exp_f32 v52, v52
    buffer_load_dwordx4 a[128:131], v6, s[36:39], s30 offen offset:2048 sc1
    v_exp_f32 v53, v53
    s_waitcnt lgkmcnt(6)
    v_mfma_f32_32x32x16_bf16 v[200:215], a[204:207], a[188:191], 0
    buffer_load_dwordx4 a[132:135], v6, s[36:39], s30 offen offset:3072 sc1
    v_cvt_pk_bf16_f32 v49, v50, v51
    v_exp_f32 v54, v54
    buffer_load_dwordx4 a[136:139], v7, s[36:39], s30 offen sc1
    v_exp_f32 v55, v55
    v_mfma_f32_32x32x16_bf16 v[200:215], a[208:211], a[192:195], v[200:215]
    ds_read_b128 a[196:199], v12 offset:6144
    ds_read_b128 a[200:203], v13 offset:7168
    v_cvt_pk_bf16_f32 v50, v52, v53
    v_cvt_pk_bf16_f32 v51, v54, v55
    v_and_b32 v52, v220, v48
    v_and_b32 v53, v221, v49
    v_and_b32 v54, v222, v50
    v_and_b32 v55, v223, v51
    v_xor_b32 v48, v52, v48
    v_xor_b32 v49, v53, v49
    v_xor_b32 v50, v54, v50
    v_xor_b32 v51, v55, v51
    v_exp_f32 v72, v72
    v_mfma_f32_32x32x16_bf16 v[24:39], a[224:227], v[52:55], v[24:39]
    s_add_u32 s30, s30, 5120
    v_cndmask_b32 v184, v200, v184, s[64:65]
    v_cndmask_b32 v185, v201, v185, s[66:67]
    v_exp_f32 v73, v73
    buffer_load_dwordx4 a[140:143], v6, s[36:39], s30 offen offset:0 sc1
    v_cndmask_b32 v186, v202, v186, s[68:69]
    v_cndmask_b32 v187, v203, v187, s[70:71]
    v_exp_f32 v74, v74
    v_cndmask_b32 v188, v204, v188, s[72:73]
    v_cndmask_b32 v189, v205, v189, s[74:75]
    v_exp_f32 v75, v75
    v_mfma_f32_32x32x16_bf16 v[24:39], a[232:235], v[48:51], v[24:39]
    v_cndmask_b32 v190, v206, v190, s[76:77]
    v_cndmask_b32 v191, v207, v191, s[78:79]
    v_cvt_pk_bf16_f32 v72, v72, v73
    v_exp_f32 v76, v76
    v_cndmask_b32 v192, v208, v192, s[80:81]
    v_cndmask_b32 v193, v209, v193, s[82:83]
    v_exp_f32 v77, v77
    v_mfma_f32_32x32x16_bf16 v[104:119], a[244:247], v[20:23], v[104:119]
    v_cndmask_b32 v194, v210, v194, s[84:85]
    v_cndmask_b32 v195, v211, v195, s[86:87]
    v_cvt_pk_bf16_f32 v73, v74, v75
    v_exp_f32 v78, v78
    v_exp_f32 v79, v79
    s_waitcnt lgkmcnt(6)
    v_mfma_f32_32x32x16_bf16 v[56:71], a[212:215], a[188:191], 0
    v_cvt_pk_bf16_f32 v74, v76, v77
    v_cvt_pk_bf16_f32 v75, v78, v79
    v_exp_f32 v80, v80
    ds_read_b64_tr_b16 a[220:221], v14 offset:4096
    v_cndmask_b32 v196, v212, v196, s[88:89]
    v_cndmask_b32 v197, v213, v197, s[90:91]
    v_exp_f32 v81, v81
    s_waitcnt lgkmcnt(3)
    v_mfma_f32_32x32x16_bf16 v[24:39], a[236:239], v[72:75], v[24:39]
    ds_read_b64_tr_b16 a[222:223], v15 offset:4096
    v_cndmask_b32 v198, v214, v198, s[92:93]
    v_cndmask_b32 v199, v215, v199, s[94:95]
    v_exp_f32 v82, v82
    ds_read_b64_tr_b16 a[224:225], v14 offset:4352
    v_max3_f32 v10, v184, v185, v186
    v_max3_f32 v11, v187, v188, v189
    v_exp_f32 v83, v83
    ds_read_b64_tr_b16 a[226:227], v15 offset:4352
    v_max3_f32 v10, v190, v191, v10
    v_max3_f32 v11, v192, v193, v11
    v_cvt_pk_bf16_f32 v80, v80, v81
    v_exp_f32 v84, v84
    buffer_load_dwordx4 a[144:147], v6, s[36:39], s30 offen offset:1024 sc1
    v_max3_f32 v10, v194, v195, v10
    v_max3_f32 v11, v196, v197, v11
    v_exp_f32 v85, v85
    v_mfma_f32_32x32x16_bf16 v[56:71], a[216:219], a[192:195], v[56:71]
    s_cmp_gt_i32 s17, 2
    s_cbranch_scc1 L_inv_10
L_inv_10r:
    ds_read_b128 a[204:207], v12 offset:8192
    ds_read_b128 a[208:211], v13 offset:9216
    buffer_load_dwordx4 a[148:151], v6, s[36:39], s30 offen offset:2048 sc1
    v_max3_f32 v10, v198, v199, v10
    v_cvt_pk_bf16_f32 v81, v82, v83
    v_exp_f32 v86, v86
    buffer_load_dwordx4 a[152:155], v6, s[36:39], s30 offen offset:3072 sc1
    v_exp_f32 v87, v87
    v_cvt_pk_bf16_f32 v82, v84, v85
    v_cvt_pk_bf16_f32 v83, v86, v87
    v_exp_f32 v88, v88
    buffer_load_dwordx4 a[156:159], v7, s[36:39], s30 offen sc1
    v_max3_f32 v10, v56, v57, v10
    v_exp_f32 v89, v89
    v_mfma_f32_32x32x16_bf16 v[24:39], a[240:243], v[80:83], v[24:39]
    s_add_u32 s30, s30, 5120
    v_max3_f32 v11, v58, v59, v11
    v_exp_f32 v90, v90
    v_max3_f32 v10, v60, v61, v10
    v_exp_f32 v91, v91
    v_max3_f32 v11, v62, v63, v11
    v_cvt_pk_bf16_f32 v88, v88, v89
    v_exp_f32 v92, v92
    v_mfma_f32_32x32x16_bf16 v[120:135], a[244:247], v[20:23], v[120:135]
    v_exp_f32 v93, v93
    v_cvt_pk_bf16_f32 v89, v90, v91
    v_exp_f32 v94, v94
    v_exp_f32 v95, v95
    s_waitcnt lgkmcnt(6)
    v_mfma_f32_32x32x16_bf16 v[200:215], a[196:199], a[188:191], 0
    v_cvt_pk_bf16_f32 v90, v92, v93
    v_cvt_pk_bf16_f32 v91, v94, v95
    v_exp_f32 v96, v96
    ds_read_b64_tr_b16 a[228:229], v14 offset:6144
    v_max3_f32 v10, v64, v65, v10
    v_exp_f32 v97, v97
    s_waitcnt lgkmcnt(3)
    v_mfma_f32_32x32x16_bf16 v[24:39], a[220:223], v[88:91], v[24:39]
    ds_read_b64_tr_b16 a[230:231], v15 offset:6144
    v_max3_f32 v11, v66, v67, v11
    v_exp_f32 v98, v98
    ds_read_b64_tr_b16 a[232:233], v14 offset:6400
    v_max3_f32 v10, v68, v69, v10
    v_exp_f32 v99, v99
    ds_read_b64_tr_b16 a[234:235], v15 offset:6400
    v_max3_f32 v11, v70, v71, v11
    v_cvt_pk_bf16_f32 v96, v96, v97
    v_exp_f32 v100, v100
    buffer_load_dwordx4 a[160:163], v6, s[36:39], s30 offen offset:0 sc1
    v_exp_f32 v101, v101
    v_mfma_f32_32x32x16_bf16 v[200:215], a[200:203], a[192:195], v[200:215]
    s_cmp_gt_i32 s17, 3
    s_cbranch_scc1 L_inv_11
L_inv_11r:
    ds_read_b128 a[212:215], v12 offset:10240
    ds_read_b128 a[216:219], v13 offset:11264
    buffer_load_dwordx4 a[164:167], v6, s[36:39], s30 offen offset:1024 sc1
    v_cvt_pk_bf16_f32 v97, v98, v99
    v_exp_f32 v102, v102
    buffer_load_dwordx4 a[168:171], v6, s[36:39], s30 offen offset:2048 sc1
    v_exp_f32 v103, v103
    v_cvt_pk_bf16_f32 v98, v100, v101
    v_cvt_pk_bf16_f32 v99, v102, v103
    v_exp_f32 v104, v104
    buffer_load_dword v251, v250, s[8:11], 0 offen sc1
    s_nop 0
    v_max3_f32 v10, v200, v201, v10
    v_exp_f32 v105, v105
    v_mfma_f32_32x32x16_bf16 v[24:39], a[224:227], v[96:99], v[24:39]
    buffer_load_dwordx4 a[172:175], v6, s[36:39], s30 offen offset:3072 sc1
    v_max3_f32 v11, v202, v203, v11
    v_exp_f32 v106, v106
    v_max3_f32 v10, v204, v205, v10
    v_exp_f32 v107, v107
    v_max3_f32 v11, v206, v207, v11
    v_cvt_pk_bf16_f32 v104, v104, v105
    v_exp_f32 v108, v108
    v_mfma_f32_32x32x16_bf16 v[136:151], a[244:247], v[20:23], v[136:151]
    v_exp_f32 v109, v109
    v_cvt_pk_bf16_f32 v105, v106, v107
    v_exp_f32 v110, v110
    v_exp_f32 v111, v111
    s_waitcnt lgkmcnt(6)
    v_mfma_f32_32x32x16_bf16 v[40:55], a[204:207], a[188:191], 0
    v_cvt_pk_bf16_f32 v106, v108, v109
    v_cvt_pk_bf16_f32 v107, v110, v111
    v_exp_f32 v112, v112
    ds_read_b64_tr_b16 a[236:237], v14 offset:8192
    v_max3_f32 v10, v208, v209, v10
    v_exp_f32 v113, v113
    s_waitcnt lgkmcnt(3)
    v_mfma_f32_32x32x16_bf16 v[24:39], a[228:231], v[104:107], v[24:39]
    ds_read_b64_tr_b16 a[238:239], v15 offset:8192
    v_max3_f32 v11, v210, v211, v11
    v_exp_f32 v114, v114
    ds_read_b64_tr_b16 a[240:241], v14 offset:8448
    v_max3_f32 v10, v212, v213, v10
    v_exp_f32 v115, v115
    ds_read_b64_tr_b16 a[242:243], v15 offset:8448
    v_max3_f32 v11, v214, v215, v11
    v_cvt_pk_bf16_f32 v112, v112, v113
    v_exp_f32 v116, v116
    buffer_load_dwordx4 a[176:179], v7, s[36:39], s30 offen sc1
    v_exp_f32 v117, v117
    v_mfma_f32_32x32x16_bf16 v[40:55], a[208:211], a[192:195], v[40:55]
    s_cmp_gt_i32 s17, 4
    s_cbranch_scc1 L_inv_12
L_inv_12r:
    ds_read_b128 a[196:199], v12 offset:12288
    ds_read_b128 a[200:203], v13 offset:13312
    s_add_u32 s36, s22, 0x1a00000
    s_addc_u32 s37, s23, 0
    s_mov_b32 s38, 0x1e0000
    s_mov_b32 s39, 0x00020000
    v_cvt_pk_bf16_f32 v113, v114, v115
    v_exp_f32 v118, v118
    buffer_load_dwordx2 v[228:229], v242, s[40:43], 0 offen offset:0
    v_exp_f32 v119, v119
    v_cvt_pk_bf16_f32 v114, v116, v117
    v_cvt_pk_bf16_f32 v115, v118, v119
    v_exp_f32 v120, v120
    buffer_load_dwordx2 v[230:231], v242, s[40:43], 0 offen offset:32
    v_max3_f32 v10, v40, v41, v10
    v_exp_f32 v121, v121
    v_mfma_f32_32x32x16_bf16 v[24:39], a[232:235], v[112:115], v[24:39]
    buffer_load_dwordx2 v[232:233], v242, s[40:43], 0 offen offset:64
    v_max3_f32 v11, v42, v43, v11
    v_exp_f32 v122, v122
    v_max3_f32 v10, v44, v45, v10
    v_exp_f32 v123, v123
    v_max3_f32 v11, v46, v47, v11
    v_cvt_pk_bf16_f32 v120, v120, v121
    v_exp_f32 v124, v124
    v_mfma_f32_32x32x16_bf16 v[152:167], a[244:247], v[20:23], v[152:167]
    v_exp_f32 v125, v125
    v_cvt_pk_bf16_f32 v121, v122, v123
    v_exp_f32 v126, v126
    v_exp_f32 v127, v127
    s_waitcnt lgkmcnt(6)
    v_mfma_f32_32x32x16_bf16 v[72:87], a[212:215], a[188:191], 0
    v_cvt_pk_bf16_f32 v122, v124, v125
    v_cvt_pk_bf16_f32 v123, v126, v127
    v_exp_f32 v128, v128
    ds_read_b64_tr_b16 a[220:221], v14 offset:10240
    v_max3_f32 v10, v48, v49, v10
    v_exp_f32 v129, v129
    s_waitcnt lgkmcnt(3)
    v_mfma_f32_32x32x16_bf16 v[24:39], a[236:239], v[120:123], v[24:39]
    ds_read_b64_tr_b16 a[222:223], v15 offset:10240
    v_max3_f32 v11, v50, v51, v11
    v_exp_f32 v130, v130
    ds_read_b64_tr_b16 a[224:225], v14 offset:10496
    v_max3_f32 v10, v52, v53, v10
    v_exp_f32 v131, v131
    ds_read_b64_tr_b16 a[226:227], v15 offset:10496
    v_max3_f32 v11, v54, v55, v11
    v_cvt_pk_bf16_f32 v128, v128, v129
    v_exp_f32 v132, v132
    buffer_load_dwordx2 v[234:235], v242, s[40:43], 0 offen offset:96
    v_exp_f32 v133, v133
    v_mfma_f32_32x32x16_bf16 v[72:87], a[216:219], a[192:195], v[72:87]
    s_cmp_gt_i32 s17, 5
    s_cbranch_scc1 L_inv_13
L_inv_13r:
    ds_read_b128 a[204:207], v12 offset:14336
    ds_read_b128 a[208:211], v13 offset:15360
    buffer_load_dwordx2 v[236:237], v242, s[40:43], 0 offen offset:128
    v_cvt_pk_bf16_f32 v129, v130, v131
    v_exp_f32 v134, v134
    s_waitcnt vmcnt(7)
    v_cmp_gt_u32 vcc, 60, v251
    s_nop 1
    s_cmp_lg_u64 vcc, 0
    s_cbranch_scc1 L_cp_slow
L_cp_ok:
    v_exp_f32 v135, v135
    v_cvt_pk_bf16_f32 v130, v132, v133
    v_cvt_pk_bf16_f32 v131, v134, v135
    v_exp_f32 v136, v136
    s_add_u32 m0, s59, 20480
    v_max3_f32 v10, v72, v73, v10
    v_exp_f32 v137, v137
    v_mfma_f32_32x32x16_bf16 v[24:39], a[240:243], v[128:131], v[24:39]
    buffer_load_dwordx4 v6, s[12:15], s16 offen offset:0 sc1 lds
    v_max3_f32 v11, v74, v75, v11
    v_exp_f32 v138, v138
    v_max3_f32 v10, v76, v77, v10
    v_exp_f32 v139, v139
    v_max3_f32 v11, v78, v79, v11
    v_cvt_pk_bf16_f32 v136, v136, v137
    v_exp_f32 v140, v140
    v_mfma_f32_32x32x16_bf16 v[168:183], a[244:247], v[20:23], v[168:183]
    v_exp_f32 v141, v141
    v_cvt_pk_bf16_f32 v137, v138, v139
    v_exp_f32 v142, v142
    v_exp_f32 v143, v143
    s_waitcnt lgkmcnt(6)
    v_mfma_f32_32x32x16_bf16 v[88:103], a[196:199], a[188:191], 0
    v_cvt_pk_bf16_f32 v138, v140, v141
    v_cvt_pk_bf16_f32 v139, v142, v143
    v_exp_f32 v144, v144
    ds_read_b64_tr_b16 a[228:229], v14 offset:12288
    v_max3_f32 v10, v80, v81, v10
    v_exp_f32 v145, v145
    s_waitcnt lgkmcnt(3)
    v_mfma_f32_32x32x16_bf16 v[24:39], a[220:223], v[136:139], v[24:39]
    ds_read_b64_tr_b16 a[230:231], v15 offset:12288
    v_max3_f32 v11, v82, v83, v11
    v_exp_f32 v146, v146
    ds_read_b64_tr_b16 a[232:233], v14 offset:12544
    v_max3_f32 v10, v84, v85, v10
    v_exp_f32 v147, v147
    ds_read_b64_tr_b16 a[234:235], v15 offset:12544
    v_max3_f32 v11, v86, v87, v11
    v_cvt_pk_bf16_f32 v144, v144, v145
    v_exp_f32 v148, v148
    buffer_load_dwordx4 v6, s[12:15], s16 offen offset:1024 sc1 lds
    v_exp_f32 v149, v149
    v_mfma_f32_32x32x16_bf16 v[88:103], a[200:203], a[192:195], v[88:103]
    s_cmp_gt_i32 s17, 6
    s_cbranch_scc1 L_inv_14
L_inv_14r:
    ds_read_b128 a[212:215], v12 offset:16384
    ds_read_b128 a[216:219], v13 offset:17408
    buffer_load_dwordx4 v6, s[12:15], s16 offen offset:2048 sc1 lds
    v_cvt_pk_bf16_f32 v145, v146, v147
    v_exp_f32 v150, v150
    buffer_load_dwordx4 v6, s[12:15], s16 offen offset:3072 sc1 lds
    v_exp_f32 v151, v151
    v_cvt_pk_bf16_f32 v146, v148, v149
    v_cvt_pk_bf16_f32 v147, v150, v151
    v_exp_f32 v152, v152
    s_add_u32 m0, s59, 24576
    s_nop 0
    v_max3_f32 v10, v88, v89, v10
    v_exp_f32 v153, v153
    v_mfma_f32_32x32x16_bf16 v[24:39], a[224:227], v[144:147], v[24:39]
    buffer_load_dwordx4 v7, s[12:15], s16 offen offset:0 sc1 lds
    v_max3_f32 v11, v90, v91, v11
    v_exp_f32 v154, v154
    v_max3_f32 v10, v92, v93, v10
    v_exp_f32 v155, v155
    v_max3_f32 v11, v94, v95, v11
    v_cvt_pk_bf16_f32 v152, v152, v153
    v_exp_f32 v156, v156
    v_exp_f32 v157, v157
    s_waitcnt lgkmcnt(6)
    v_mfma_f32_32x32x16_bf16 v[104:119], a[204:207], a[188:191], 0
    v_cvt_pk_bf16_f32 v153, v154, v155
    v_exp_f32 v158, v158
    v_exp_f32 v159, v159
    v_cvt_pk_bf16_f32 v154, v156, v157
    v_cvt_pk_bf16_f32 v155, v158, v159
    v_exp_f32 v160, v160
    ds_read_b64_tr_b16 a[236:237], v14 offset:14336
    v_max3_f32 v10, v96, v97, v10
    v_exp_f32 v161, v161
    s_waitcnt lgkmcnt(3)
    v_mfma_f32_32x32x16_bf16 v[24:39], a[228:231], v[152:155], v[24:39]
    ds_read_b64_tr_b16 a[238:239], v15 offset:14336
    v_max3_f32 v11, v98, v99, v11
    v_exp_f32 v162, v162
    ds_read_b64_tr_b16 a[240:241], v14 offset:14592
    v_max3_f32 v10, v100, v101, v10
    v_exp_f32 v163, v163
    ds_read_b64_tr_b16 a[242:243], v15 offset:14592
    v_max3_f32 v11, v102, v103, v11
    v_cvt_pk_bf16_f32 v160, v160, v161
    v_exp_f32 v164, v164
    s_add_u32 s16, s16, 20480
    v_exp_f32 v165, v165
    v_mfma_f32_32x32x16_bf16 v[104:119], a[208:211], a[192:195], v[104:119]
    s_cmp_gt_i32 s17, 7
    s_cbranch_scc1 L_inv_15
L_inv_15r:
    s_add_u32 m0, s59, 40960
    v_cvt_pk_bf16_f32 v161, v162, v163
    v_exp_f32 v166, v166
    buffer_load_dwordx4 v6, s[12:15], s16 offen offset:0 sc1 lds
    v_exp_f32 v167, v167
    v_cvt_pk_bf16_f32 v162, v164, v165
    v_cvt_pk_bf16_f32 v163, v166, v167
    v_exp_f32 v168, v168
    buffer_load_dwordx4 v6, s[12:15], s16 offen offset:1024 sc1 lds
    s_nop 2
    v_max3_f32 v10, v104, v105, v10
    v_exp_f32 v169, v169
    v_mfma_f32_32x32x16_bf16 v[24:39], a[232:235], v[160:163], v[24:39]
    buffer_load_dwordx4 v6, s[12:15], s16 offen offset:2048 sc1 lds
    v_max3_f32 v11, v106, v107, v11
    v_exp_f32 v170, v170
    v_max3_f32 v10, v108, v109, v10
    v_exp_f32 v171, v171
    v_max3_f32 v11, v110, v111, v11
    v_cvt_pk_bf16_f32 v168, v168, v169
    v_exp_f32 v172, v172
    v_exp_f32 v173, v173
    s_waitcnt lgkmcnt(4)
    v_mfma_f32_32x32x16_bf16 v[120:135], a[212:215], a[188:191], 0
    v_cvt_pk_bf16_f32 v169, v170, v171
    v_exp_f32 v174, v174
    v_exp_f32 v175, v175
    v_cvt_pk_bf16_f32 v170, v172, v173
    v_cvt_pk_bf16_f32 v171, v174, v175
    v_exp_f32 v176, v176
    buffer_load_dwordx4 v6, s[12:15], s16 offen offset:3072 sc1 lds
    v_max3_f32 v10, v112, v113, v10
    v_exp_f32 v177, v177
    s_waitcnt lgkmcnt(0)
    v_mfma_f32_32x32x16_bf16 v[24:39], a[236:239], v[168:171], v[24:39]
    s_add_u32 m0, s59, 45056
    v_max3_f32 v11, v114, v115, v11
    v_exp_f32 v178, v178
    buffer_load_dwordx4 v7, s[12:15], s16 offen offset:0 sc1 lds
    v_max3_f32 v10, v116, v117, v10
    v_exp_f32 v179, v179
    v_max3_f32 v11, v118, v119, v11
    v_cvt_pk_bf16_f32 v176, v176, v177
    v_exp_f32 v180, v180
    v_exp_f32 v181, v181
    v_mfma_f32_32x32x16_bf16 v[120:135], a[216:219], a[192:195], v[120:135]
    v_cvt_pk_bf16_f32 v177, v178, v179
    v_exp_f32 v182, v182
    v_exp_f32 v183, v183
    v_cvt_pk_bf16_f32 v178, v180, v181
    v_cvt_pk_bf16_f32 v179, v182, v183
    s_nop 1
    v_mfma_f32_32x32x16_bf16 v[24:39], a[240:243], v[176:179], v[24:39]
    ds_read_b64_tr_b16 a[220:221], v14 offset:2048
    ds_read_b64_tr_b16 a[222:223], v15 offset:2048
    ds_read_b64_tr_b16 a[224:225], v14 offset:2304
    ds_read_b64_tr_b16 a[226:227], v15 offset:2304
    ds_read_b64_tr_b16 a[228:229], v14 offset:18432
    ds_read_b64_tr_b16 a[230:231], v15 offset:18432
    ds_read_b64_tr_b16 a[232:233], v14 offset:18688
    ds_read_b64_tr_b16 a[234:235], v15 offset:18688
    v_max3_f32 v10, v120, v121, v10
    v_max3_f32 v11, v122, v123, v11
    v_max3_f32 v10, v124, v125, v10
    v_max3_f32 v11, v126, v127, v11
    v_max3_f32 v10, v128, v129, v10
    v_max3_f32 v11, v130, v131, v11
    v_max3_f32 v10, v132, v133, v10
    v_max3_f32 v11, v134, v135, v11
    v_max_f32 v10, v10, v11
    v_mov_b32 v11, v10
    v_cmp_gt_u32 vcc, 32, v1
    s_nop 0
    v_permlane32_swap_b32 v10, v11
    v_max_f32 v10, v10, v11
    v_cndmask_b32 v10, 0, -v10, vcc
    v_and_b32 v2, 0xffff0000, v10
    v_sub_f32 v2, v10, v2
    v_and_b32 v3, 0xffff0000, v2
    v_sub_f32 v3, v2, v3
    v_perm_b32 v20, v2, v10, s61
    v_lshrrev_b32 v21, 16, v3
    v_rcp_f32 v4, v36
    s_nop 0
    v_mov_b32 v5, v4
    v_pk_mul_f32 v[24:25], v[24:25], v[4:5]
    v_pk_mul_f32 v[26:27], v[26:27], v[4:5]
    v_pk_mul_f32 v[28:29], v[28:29], v[4:5]
    v_pk_mul_f32 v[30:31], v[30:31], v[4:5]
    v_pk_mul_f32 v[32:33], v[32:33], v[4:5]
    v_pk_mul_f32 v[34:35], v[34:35], v[4:5]
    v_cvt_pk_bf16_f32 v168, v24, v25
    v_cvt_pk_bf16_f32 v169, v26, v27
    v_cvt_pk_bf16_f32 v170, v28, v29
    v_cvt_pk_bf16_f32 v171, v30, v31
    v_cvt_pk_bf16_f32 v172, v32, v33
    v_cvt_pk_bf16_f32 v173, v34, v35
    buffer_store_dwordx4 v[168:171], v16, s[44:47], 0 offen sc1
    buffer_store_dwordx2 v[172:173], v17, s[44:47], 0 offen sc1
    s_lshl_b32 s27, s25, 3
    s_add_u32 s27, s27, s24
    s_lshl_b32 s27, s27, 7
    s_add_u32 s6, s27, 57344
    v_add_u32 v250, 0x1000, v240
    v_add_u32 v251, 0x1000, v241
    s_min_u32 s98, s56, s57
    s_max_u32 s99, s56, s57
    v_mfma_f32_32x32x16_bf16 v[184:199], a[244:247], v[20:23], v[184:199]
    v_mfma_f32_32x32x16_bf16 v[56:71], a[244:247], v[20:23], v[56:71]
    s_nop 10
    v_exp_f32 v184, v184
    s_add_u32 s16, s16, 20480
    v_exp_f32 v185, v185
    v_mfma_f32_32x32x16_bf16 v[200:215], a[244:247], v[20:23], v[200:215]
    s_add_u32 m0, s59, 61440
    v_exp_f32 v186, v186
    buffer_load_dwordx4 v6, s[12:15], s16 offen offset:0 sc1 lds
    v_exp_f32 v187, v187
    v_cvt_pk_bf16_f32 v184, v184, v185
    v_exp_f32 v188, v188
    v_exp_f32 v189, v189
    v_cvt_pk_bf16_f32 v185, v186, v187
    v_exp_f32 v190, v190
    v_exp_f32 v191, v191
    v_cvt_pk_bf16_f32 v186, v188, v189
    v_cvt_pk_bf16_f32 v187, v190, v191
    v_and_b32 v188, v216, v184
    v_and_b32 v189, v217, v185
    v_and_b32 v190, v218, v186
    v_and_b32 v191, v219, v187
    v_xor_b32 v184, v188, v184
    v_xor_b32 v185, v189, v185
    v_xor_b32 v186, v190, v186
    v_xor_b32 v187, v191, v187
    v_exp_f32 v192, v192
    ds_read_b64_tr_b16 a[236:237], v14 offset:4096
    v_exp_f32 v193, v193
    s_waitcnt lgkmcnt(1)
    v_mfma_f32_32x32x16_bf16 v[24:39], a[220:223], v[188:191], 0
    ds_read_b64_tr_b16 a[238:239], v15 offset:4096
    v_exp_f32 v194, v194
    ds_read_b64_tr_b16 a[240:241], v14 offset:4352
    v_exp_f32 v195, v195
    ds_read_b64_tr_b16 a[242:243], v15 offset:4352
    v_cvt_pk_bf16_f32 v192, v192, v193
    v_exp_f32 v196, v196
    buffer_load_dwordx4 v6, s[12:15], s16 offen offset:1024 sc1 lds
    v_exp_f32 v197, v197
    v_mfma_f32_32x32x16_bf16 v[24:39], a[228:231], v[184:187], v[24:39]
    buffer_load_dwordx4 v6, s[12:15], s16 offen offset:2048 sc1 lds
    v_cvt_pk_bf16_f32 v193, v194, v195
    v_exp_f32 v198, v198
    buffer_load_dwordx4 v6, s[12:15], s16 offen offset:3072 sc1 lds
    v_exp_f32 v199, v199
    v_cvt_pk_bf16_f32 v194, v196, v197
    v_cvt_pk_bf16_f32 v195, v198, v199
    v_and_b32 v196, v220, v192
    v_and_b32 v197, v221, v193
    v_and_b32 v198, v222, v194
    v_and_b32 v199, v223, v195
    v_xor_b32 v192, v196, v192
    v_xor_b32 v193, v197, v193
    v_xor_b32 v194, v198, v194
    v_xor_b32 v195, v199, v195
    v_exp_f32 v56, v56
    s_add_u32 m0, s59, 65536
    v_exp_f32 v57, v57
    v_mfma_f32_32x32x16_bf16 v[24:39], a[224:227], v[196:199], v[24:39]
    buffer_load_dwordx4 v7, s[12:15], s16 offen offset:0 sc1 lds
    v_exp_f32 v58, v58
    s_add_u32 s16, s16, 20480
    v_exp_f32 v59, v59
    v_cvt_pk_bf16_f32 v56, v56, v57
    v_exp_f32 v60, v60
    v_mfma_f32_32x32x16_bf16 v[24:39], a[232:235], v[192:195], v[24:39]
    v_exp_f32 v61, v61
    v_cvt_pk_bf16_f32 v57, v58, v59
    v_exp_f32 v62, v62
    v_exp_f32 v63, v63
    v_mfma_f32_32x32x16_bf16 v[40:55], a[244:247], v[20:23], v[40:55]
    v_cvt_pk_bf16_f32 v58, v60, v61
    v_cvt_pk_bf16_f32 v59, v62, v63
    v_exp_f32 v64, v64
    ds_read_b64_tr_b16 a[220:221], v14 offset:6144
    v_exp_f32 v65, v65
    s_waitcnt lgkmcnt(1)
    v_mfma_f32_32x32x16_bf16 v[24:39], a[236:239], v[56:59], v[24:39]
    ds_read_b64_tr_b16 a[222:223], v15 offset:6144
    v_exp_f32 v66, v66
    ds_read_b64_tr_b16 a[224:225], v14 offset:6400
    v_exp_f32 v67, v67
    ds_read_b64_tr_b16 a[226:227], v15 offset:6400
    v_cvt_pk_bf16_f32 v64, v64, v65
    v_exp_f32 v68, v68
    s_add_u32 m0, s59, 81920
    v_exp_f32 v69, v69
    buffer_load_dwordx4 v6, s[12:15], s16 offen offset:0 sc1 lds
    v_cvt_pk_bf16_f32 v65, v66, v67
    v_exp_f32 v70, v70
    buffer_load_dwordx4 v6, s[12:15], s16 offen offset:1024 sc1 lds
    v_exp_f32 v71, v71
    v_cvt_pk_bf16_f32 v66, v68, v69
    v_cvt_pk_bf16_f32 v67, v70, v71
    v_exp_f32 v200, v200
    buffer_load_dwordx4 v6, s[12:15], s16 offen offset:2048 sc1 lds
    v_exp_f32 v201, v201
    v_mfma_f32_32x32x16_bf16 v[24:39], a[240:243], v[64:67], v[24:39]
    buffer_load_dwordx4 v6, s[12:15], s16 offen offset:3072 sc1 lds
    v_exp_f32 v202, v202
    s_add_u32 m0, s59, 86016
    v_exp_f32 v203, v203
    v_cvt_pk_bf16_f32 v200, v200, v201
    v_exp_f32 v204, v204
    v_exp_f32 v205, v205
    v_mfma_f32_32x32x16_bf16 v[72:87], a[244:247], v[20:23], v[72:87]
    v_cvt_pk_bf16_f32 v201, v202, v203
    v_exp_f32 v206, v206
    v_exp_f32 v207, v207
    v_cvt_pk_bf16_f32 v202, v204, v205
    v_cvt_pk_bf16_f32 v203, v206, v207
    v_exp_f32 v208, v208
    ds_read_b64_tr_b16 a[228:229], v14 offset:8192
    v_exp_f32 v209, v209
    s_waitcnt lgkmcnt(1)
    v_mfma_f32_32x32x16_bf16 v[24:39], a[220:223], v[200:203], v[24:39]
    ds_read_b64_tr_b16 a[230:231], v15 offset:8192
    v_exp_f32 v210, v210
    ds_read_b64_tr_b16 a[232:233], v14 offset:8448
    v_exp_f32 v211, v211
    ds_read_b64_tr_b16 a[234:235], v15 offset:8448
    v_cvt_pk_bf16_f32 v208, v208, v209
    v_exp_f32 v212, v212
    buffer_load_dwordx4 v7, s[12:15], s16 offen offset:0 sc1 lds
    v_exp_f32 v213, v213
    s_add_u32 s16, s16, 20480
    v_cvt_pk_bf16_f32 v209, v210, v211
    v_exp_f32 v214, v214
    s_add_u32 s30, s58, 0
    v_exp_f32 v215, v215
    v_cvt_pk_bf16_f32 v210, v212, v213
    v_cvt_pk_bf16_f32 v211, v214, v215
    v_exp_f32 v40, v40
    buffer_load_dwordx4 a[0:3], v6, s[36:39], s30 offen offset:0 sc1
    v_exp_f32 v41, v41
    v_mfma_f32_32x32x16_bf16 v[24:39], a[224:227], v[208:211], v[24:39]
    buffer_load_dwordx4 a[4:7], v6, s[36:39], s30 offen offset:1024 sc1
    v_exp_f32 v42, v42
    buffer_load_dwordx4 a[8:11], v6, s[36:39], s30 offen offset:2048 sc1
    v_exp_f32 v43, v43
    v_cvt_pk_bf16_f32 v40, v40, v41
    v_exp_f32 v44, v44
    v_exp_f32 v45, v45
    v_mfma_f32_32x32x16_bf16 v[88:103], a[244:247], v[20:23], v[88:103]
    v_cvt_pk_bf16_f32 v41, v42, v43
    v_exp_f32 v46, v46
    v_exp_f32 v47, v47
    v_cvt_pk_bf16_f32 v42, v44, v45
    v_cvt_pk_bf16_f32 v43, v46, v47
    v_exp_f32 v48, v48
    ds_read_b64_tr_b16 a[236:237], v14 offset:10240
    v_exp_f32 v49, v49
    s_waitcnt lgkmcnt(1)
    v_mfma_f32_32x32x16_bf16 v[24:39], a[228:231], v[40:43], v[24:39]
    ds_read_b64_tr_b16 a[238:239], v15 offset:10240
    v_exp_f32 v50, v50
    ds_read_b64_tr_b16 a[240:241], v14 offset:10496
    v_exp_f32 v51, v51
    ds_read_b64_tr_b16 a[242:243], v15 offset:10496
    v_cvt_pk_bf16_f32 v48, v48, v49
    v_exp_f32 v52, v52
    buffer_load_dwordx4 a[12:15], v6, s[36:39], s30 offen offset:3072 sc1
    v_exp_f32 v53, v53
    buffer_load_dwordx4 a[16:19], v7, s[36:39], s30 offen sc1
    v_cvt_pk_bf16_f32 v49, v50, v51
    v_exp_f32 v54, v54
    s_add_u32 s30, s58, 15360
    v_exp_f32 v55, v55
    s_waitcnt vmcnt(15)
    s_mov_b64 exec, 1
    buffer_atomic_add v9, v8, s[8:11], s20 offen offset:0 sc1
    s_mov_b64 exec, -1
    v_cvt_pk_bf16_f32 v50, v52, v53
    v_cvt_pk_bf16_f32 v51, v54, v55
    v_exp_f32 v72, v72
    buffer_load_dwordx4 a[20:23], v6, s[36:39], s30 offen offset:0 sc1
    v_exp_f32 v73, v73
    v_mfma_f32_32x32x16_bf16 v[24:39], a[232:235], v[48:51], v[24:39]
    buffer_load_dwordx4 a[24:27], v6, s[36:39], s30 offen offset:1024 sc1
    v_exp_f32 v74, v74
    buffer_load_dwordx4 a[28:31], v6, s[36:39], s30 offen offset:2048 sc1
    v_exp_f32 v75, v75
    v_cvt_pk_bf16_f32 v72, v72, v73
    v_exp_f32 v76, v76
    v_exp_f32 v77, v77
    v_mfma_f32_32x32x16_bf16 v[104:119], a[244:247], v[20:23], v[104:119]
    v_cvt_pk_bf16_f32 v73, v74, v75
    v_exp_f32 v78, v78
    v_exp_f32 v79, v79
    v_cvt_pk_bf16_f32 v74, v76, v77
    v_cvt_pk_bf16_f32 v75, v78, v79
    v_exp_f32 v80, v80
    ds_read_b64_tr_b16 a[220:221], v14 offset:12288
    v_exp_f32 v81, v81
    s_waitcnt lgkmcnt(1)
    v_mfma_f32_32x32x16_bf16 v[24:39], a[236:239], v[72:75], v[24:39]
    ds_read_b64_tr_b16 a[222:223], v15 offset:12288
    v_exp_f32 v82, v82
    ds_read_b64_tr_b16 a[224:225], v14 offset:12544
    v_exp_f32 v83, v83
    ds_read_b64_tr_b16 a[226:227], v15 offset:12544
    v_cvt_pk_bf16_f32 v80, v80, v81
    v_exp_f32 v84, v84
    buffer_load_dwordx4 a[32:35], v6, s[36:39], s30 offen offset:3072 sc1
    v_exp_f32 v85, v85
    buffer_load_dwordx4 a[36:39], v7, s[36:39], s30 offen sc1
    v_cvt_pk_bf16_f32 v81, v82, v83
    v_exp_f32 v86, v86
    s_add_u32 s30, s58, 30720
    v_exp_f32 v87, v87
    v_cvt_pk_bf16_f32 v82, v84, v85
    v_cvt_pk_bf16_f32 v83, v86, v87
    v_exp_f32 v88, v88
    buffer_load_dwordx4 a[40:43], v6, s[36:39], s30 offen offset:0 sc1
    v_exp_f32 v89, v89
    v_mfma_f32_32x32x16_bf16 v[24:39], a[240:243], v[80:83], v[24:39]
    buffer_load_dwordx4 a[44:47], v6, s[36:39], s30 offen offset:1024 sc1
    v_exp_f32 v90, v90
    buffer_load_dwordx4 a[48:51], v6, s[36:39], s30 offen offset:2048 sc1
    v_exp_f32 v91, v91
    v_cvt_pk_bf16_f32 v88, v88, v89
    v_exp_f32 v92, v92
    v_exp_f32 v93, v93
    v_mfma_f32_32x32x16_bf16 v[120:135], a[244:247], v[20:23], v[120:135]
    v_cvt_pk_bf16_f32 v89, v90, v91
    v_exp_f32 v94, v94
    v_exp_f32 v95, v95
    v_cvt_pk_bf16_f32 v90, v92, v93
    v_cvt_pk_bf16_f32 v91, v94, v95
    v_exp_f32 v96, v96
    ds_read_b64_tr_b16 a[228:229], v14 offset:14336
    v_exp_f32 v97, v97
    s_waitcnt lgkmcnt(1)
    v_mfma_f32_32x32x16_bf16 v[24:39], a[220:223], v[88:91], v[24:39]
    ds_read_b64_tr_b16 a[230:231], v15 offset:14336
    v_exp_f32 v98, v98
    ds_read_b64_tr_b16 a[232:233], v14 offset:14592
    v_exp_f32 v99, v99
    ds_read_b64_tr_b16 a[234:235], v15 offset:14592
    v_cvt_pk_bf16_f32 v96, v96, v97
    v_exp_f32 v100, v100
    buffer_load_dwordx4 a[52:55], v6, s[36:39], s30 offen offset:3072 sc1
    v_exp_f32 v101, v101
    buffer_load_dwordx4 a[56:59], v7, s[36:39], s30 offen sc1
    v_cvt_pk_bf16_f32 v97, v98, v99
    v_exp_f32 v102, v102
    s_add_u32 s30, s58, 46080
    v_exp_f32 v103, v103
    v_cvt_pk_bf16_f32 v98, v100, v101
    v_cvt_pk_bf16_f32 v99, v102, v103
    v_exp_f32 v104, v104
    buffer_load_dwordx4 a[60:63], v6, s[36:39], s30 offen offset:0 sc1
    v_exp_f32 v105, v105
    v_mfma_f32_32x32x16_bf16 v[24:39], a[224:227], v[96:99], v[24:39]
    buffer_load_dwordx4 a[64:67], v6, s[36:39], s30 offen offset:1024 sc1
    v_exp_f32 v106, v106
    v_exp_f32 v107, v107
    v_cvt_pk_bf16_f32 v104, v104, v105
    v_exp_f32 v108, v108
    v_exp_f32 v109, v109
    v_cvt_pk_bf16_f32 v105, v106, v107
    v_exp_f32 v110, v110
    v_exp_f32 v111, v111
    v_cvt_pk_bf16_f32 v106, v108, v109
    v_cvt_pk_bf16_f32 v107, v110, v111
    v_exp_f32 v112, v112
    ds_read_b64_tr_b16 a[236:237], v14 offset:16384
    v_exp_f32 v113, v113
    s_waitcnt lgkmcnt(1)
    v_mfma_f32_32x32x16_bf16 v[24:39], a[228:231], v[104:107], v[24:39]
    ds_read_b64_tr_b16 a[238:239], v15 offset:16384
    v_exp_f32 v114, v114
    ds_read_b64_tr_b16 a[240:241], v14 offset:16640
    v_exp_f32 v115, v115
    ds_read_b64_tr_b16 a[242:243], v15 offset:16640
    v_cvt_pk_bf16_f32 v112, v112, v113
    v_exp_f32 v116, v116
    buffer_load_dwordx4 a[68:71], v6, s[36:39], s30 offen offset:2048 sc1
    v_exp_f32 v117, v117
    buffer_load_dwordx4 a[72:75], v6, s[36:39], s30 offen offset:3072 sc1
    v_cvt_pk_bf16_f32 v113, v114, v115
    v_exp_f32 v118, v118
    buffer_load_dwordx4 a[76:79], v7, s[36:39], s30 offen sc1
    v_exp_f32 v119, v119
    v_cvt_pk_bf16_f32 v114, v116, v117
    v_cvt_pk_bf16_f32 v115, v118, v119
    v_exp_f32 v120, v120
    v_exp_f32 v121, v121
    v_mfma_f32_32x32x16_bf16 v[24:39], a[232:235], v[112:115], v[24:39]
    v_exp_f32 v122, v122
    v_exp_f32 v123, v123
    v_cvt_pk_bf16_f32 v120, v120, v121
    v_exp_f32 v124, v124
    v_exp_f32 v125, v125
    v_cvt_pk_bf16_f32 v121, v122, v123
    v_exp_f32 v126, v126
    v_exp_f32 v127, v127
    v_cvt_pk_bf16_f32 v122, v124, v125
    v_cvt_pk_bf16_f32 v123, v126, v127
    v_exp_f32 v128, v128
    v_mov_b32 v239, 0
    s_mov_b64 exec, 1
    buffer_atomic_add v239, v8, s[8:11], s6 offen offset:0 sc0 sc1
    s_mov_b64 exec, -1
    v_exp_f32 v129, v129
    s_waitcnt lgkmcnt(0)
    v_mfma_f32_32x32x16_bf16 v[24:39], a[236:239], v[120:123], v[24:39]
    v_exp_f32 v130, v130
    v_exp_f32 v131, v131
    v_cvt_pk_bf16_f32 v128, v128, v129
    v_exp_f32 v132, v132
    v_exp_f32 v133, v133
    v_cvt_pk_bf16_f32 v129, v130, v131
    v_exp_f32 v134, v134
    v_exp_f32 v135, v135
    v_cvt_pk_bf16_f32 v130, v132, v133
    v_cvt_pk_bf16_f32 v131, v134, v135
    s_nop 1
    v_mfma_f32_32x32x16_bf16 v[24:39], a[240:243], v[128:131], v[24:39]
    s_nop 11
    v_rcp_f32 v4, v36
    s_nop 0
    v_mov_b32 v5, v4
    v_pk_mul_f32 v[24:25], v[24:25], v[4:5]
    v_pk_mul_f32 v[26:27], v[26:27], v[4:5]
    v_pk_mul_f32 v[28:29], v[28:29], v[4:5]
    v_pk_mul_f32 v[30:31], v[30:31], v[4:5]
    v_pk_mul_f32 v[32:33], v[32:33], v[4:5]
    v_pk_mul_f32 v[34:35], v[34:35], v[4:5]
    v_cvt_pk_bf16_f32 v176, v24, v25
    v_cvt_pk_bf16_f32 v177, v26, v27
    v_cvt_pk_bf16_f32 v178, v28, v29
    v_cvt_pk_bf16_f32 v179, v30, v31
    v_cvt_pk_bf16_f32 v180, v32, v33
    v_cvt_pk_bf16_f32 v181, v34, v35
    buffer_store_dwordx4 v[176:179], v16, s[44:47], s21 offen sc1
    buffer_store_dwordx2 v[180:181], v17, s[44:47], s21 offen sc1
    s_add_u32 s40, s22, 0x1420000
    s_addc_u32 s41, s23, 0
    s_mov_b32 s42, 0xf000
    s_mov_b32 s43, 0x00020000
    v_lshlrev_b32 v5, 2, v18
    v_mul_u32_u24 v3, 6144, v19
    v_add_u32 v5, v5, v3
    s_mul_i32 s27, s53, 384
    buffer_load_dword v184, v5, s[40:43], s27 offen offset:0 sc1
    buffer_load_dword v185, v5, s[40:43], s27 offen offset:128 sc1
    buffer_load_dword v186, v5, s[40:43], s27 offen offset:256 sc1
    s_add_u32 s27, s27, 12288
    buffer_load_dword v187, v5, s[40:43], s27 offen offset:0 sc1
    buffer_load_dword v188, v5, s[40:43], s27 offen offset:128 sc1
    buffer_load_dword v189, v5, s[40:43], s27 offen offset:256 sc1
    s_add_u32 s27, s27, 12288
    buffer_load_dword v190, v5, s[40:43], s27 offen offset:0 sc1
    buffer_load_dword v191, v5, s[40:43], s27 offen offset:128 sc1
    buffer_load_dword v192, v5, s[40:43], s27 offen offset:256 sc1
    s_add_u32 s27, s27, 12288
    buffer_load_dword v193, v5, s[40:43], s27 offen offset:0 sc1
    buffer_load_dword v194, v5, s[40:43], s27 offen offset:128 sc1
    buffer_load_dword v195, v5, s[40:43], s27 offen offset:256 sc1
    s_add_u32 s27, s27, 12288
    buffer_load_dword v196, v5, s[40:43], s27 offen offset:0 sc1
    buffer_load_dword v197, v5, s[40:43], s27 offen offset:128 sc1
    buffer_load_dword v198, v5, s[40:43], s27 offen offset:256 sc1
    s_add_u32 s27, s27, 12288
    s_add_u32 s44, s22, 0xb00000
    s_addc_u32 s45, s23, 0
    s_mov_b32 s46, 0x280000
    s_mov_b32 s47, 0x00020000
    s_waitcnt vmcnt(15)
    s_mov_b64 exec, 1
    buffer_atomic_add v9, v8, s[8:11], s20 offen offset:512 sc1
    s_mov_b64 exec, -1
    s_waitcnt vmcnt(18)
    v_readfirstlane_b32 s28, v239
    s_nop 1
    s_cmp_lt_u32 s28, 8
    s_cbranch_scc1 L_p3slow_0
L_p3ok_0:
    buffer_load_dwordx4 a[180:183], v240, s[32:35], s98 offen offset:0 sc1
    buffer_load_dwordx4 a[184:187], v241, s[32:35], s98 offen offset:0 sc1
    buffer_load_dwordx4 a[196:199], v240, s[32:35], s98 offen offset:2048 sc1
    buffer_load_dwordx4 a[200:203], v241, s[32:35], s98 offen offset:2048 sc1
    buffer_load_dwordx4 a[212:215], v250, s[32:35], s98 offen offset:0 sc1
    buffer_load_dwordx4 a[216:219], v251, s[32:35], s98 offen offset:0 sc1
    buffer_load_dwordx4 a[228:231], v250, s[32:35], s98 offen offset:2048 sc1
    buffer_load_dwordx4 a[232:235], v251, s[32:35], s98 offen offset:2048 sc1
    buffer_load_dwordx2 v[128:129], v248, s[32:35], s98 offen offset:0 sc1
    buffer_load_dwordx2 v[130:131], v248, s[32:35], s98 offen offset:512 sc1
    buffer_load_dwordx2 v[132:133], v249, s[32:35], s98 offen offset:0 sc1
    buffer_load_dwordx2 v[134:135], v249, s[32:35], s98 offen offset:512 sc1
    v_mov_b32 v239, 0
    s_mov_b64 exec, 1
    buffer_atomic_add v239, v8, s[8:11], s6 offen offset:512 sc0 sc1
    s_mov_b64 exec, -1
    s_mul_i32 s27, s24, 20480
    v_add_u32 v144, s27, v6
    s_xor_b32 s27, s24, 0
    s_mul_i32 s27, s27, 5120
    s_add_u32 s27, s27, 0
    v_add_u32 v10, s27, v6
    s_xor_b32 s27, s24, 1
    s_mul_i32 s27, s27, 5120
    s_add_u32 s27, s27, 20480
    v_add_u32 v11, s27, v6
    s_xor_b32 s27, s24, 0
    s_mul_i32 s27, s27, 5120
    s_add_u32 s27, s27, 40960
    v_add_u32 v12, s27, v6
    s_xor_b32 s27, s24, 1
    s_mul_i32 s27, s27, 5120
    s_add_u32 s27, s27, 61440
    v_add_u32 v13, s27, v6
    v_lshlrev_b32 v20, 16, v228
    v_and_b32 v21, s52, v228
    v_lshlrev_b32 v22, 16, v229
    v_and_b32 v23, s52, v229
    v_lshlrev_b32 v24, 16, v230
    v_and_b32 v25, s52, v230
    v_lshlrev_b32 v26, 16, v231
    v_and_b32 v27, s52, v231
    v_lshlrev_b32 v28, 16, v232
    v_and_b32 v29, s52, v232
    v_lshlrev_b32 v30, 16, v233
    v_and_b32 v31, s52, v233
    v_lshlrev_b32 v32, 16, v234
    v_and_b32 v33, s52, v234
    v_lshlrev_b32 v34, 16, v235
    v_and_b32 v35, s52, v235
    v_lshlrev_b32 v36, 16, v236
    v_and_b32 v37, s52, v236
    v_lshlrev_b32 v38, 16, v237
    v_and_b32 v39, s52, v237
    s_waitcnt vmcnt(14)
    v_add_f32 v145, v184, v187
    v_add_f32 v146, v185, v188
    v_add_f32 v147, v186, v189
    v_add_f32 v145, v145, v190
    v_add_f32 v146, v146, v191
    v_add_f32 v147, v147, v192
    v_add_f32 v145, v145, v193
    v_add_f32 v146, v146, v194
    v_add_f32 v147, v147, v195
    v_add_f32 v145, v145, v196
    v_add_f32 v146, v146, v197
    v_add_f32 v147, v147, v198
    s_barrier
    s_waitcnt vmcnt(11)
    v_mfma_f32_16x16x32_bf16 v[40:43], a[80:83], a[180:183], 0
    v_mfma_f32_16x16x32_bf16 v[60:63], a[80:83], a[184:187], 0
    v_mfma_f32_16x16x32_bf16 v[44:47], a[84:87], a[180:183], 0
    v_mfma_f32_16x16x32_bf16 v[64:67], a[84:87], a[184:187], 0
    v_mfma_f32_16x16x32_bf16 v[48:51], a[88:91], a[180:183], 0
    v_mfma_f32_16x16x32_bf16 v[68:71], a[88:91], a[184:187], 0
    v_mfma_f32_16x16x32_bf16 v[52:55], a[92:95], a[180:183], 0
    v_mfma_f32_16x16x32_bf16 v[72:75], a[92:95], a[184:187], 0
    v_mfma_f32_16x16x32_bf16 v[56:59], a[96:99], a[180:183], 0
    v_mfma_f32_16x16x32_bf16 v[76:79], a[96:99], a[184:187], 0
    s_waitcnt vmcnt(9)
    v_mfma_f32_16x16x32_bf16 v[40:43], a[100:103], a[196:199], v[40:43]
    v_mfma_f32_16x16x32_bf16 v[60:63], a[100:103], a[200:203], v[60:63]
    v_mfma_f32_16x16x32_bf16 v[44:47], a[104:107], a[196:199], v[44:47]
    v_mfma_f32_16x16x32_bf16 v[64:67], a[104:107], a[200:203], v[64:67]
    v_mfma_f32_16x16x32_bf16 v[48:51], a[108:111], a[196:199], v[48:51]
    v_mfma_f32_16x16x32_bf16 v[68:71], a[108:111], a[200:203], v[68:71]
    v_mfma_f32_16x16x32_bf16 v[52:55], a[112:115], a[196:199], v[52:55]
    v_mfma_f32_16x16x32_bf16 v[72:75], a[112:115], a[200:203], v[72:75]
    v_mfma_f32_16x16x32_bf16 v[56:59], a[116:119], a[196:199], v[56:59]
    v_mfma_f32_16x16x32_bf16 v[76:79], a[116:119], a[200:203], v[76:79]
    s_waitcnt vmcnt(7)
    v_mfma_f32_16x16x32_bf16 v[40:43], a[120:123], a[212:215], v[40:43]
    v_mfma_f32_16x16x32_bf16 v[60:63], a[120:123], a[216:219], v[60:63]
    v_mfma_f32_16x16x32_bf16 v[44:47], a[124:127], a[212:215], v[44:47]
    v_mfma_f32_16x16x32_bf16 v[64:67], a[124:127], a[216:219], v[64:67]
    v_mfma_f32_16x16x32_bf16 v[48:51], a[128:131], a[212:215], v[48:51]
    v_mfma_f32_16x16x32_bf16 v[68:71], a[128:131], a[216:219], v[68:71]
    v_mfma_f32_16x16x32_bf16 v[52:55], a[132:135], a[212:215], v[52:55]
    v_mfma_f32_16x16x32_bf16 v[72:75], a[132:135], a[216:219], v[72:75]
    v_mfma_f32_16x16x32_bf16 v[56:59], a[136:139], a[212:215], v[56:59]
    v_mfma_f32_16x16x32_bf16 v[76:79], a[136:139], a[216:219], v[76:79]
    s_waitcnt vmcnt(0)
    v_readfirstlane_b32 s28, v239
    s_nop 1
    s_cmp_lt_u32 s28, 8
    s_cbranch_scc1 L_p3slow_1
L_p3ok_1:
    buffer_load_dwordx4 a[188:191], v240, s[32:35], s99 offen offset:0 sc1
    buffer_load_dwordx4 a[192:195], v241, s[32:35], s99 offen offset:0 sc1
    buffer_load_dwordx4 a[204:207], v240, s[32:35], s99 offen offset:2048 sc1
    buffer_load_dwordx4 a[208:211], v241, s[32:35], s99 offen offset:2048 sc1
    buffer_load_dwordx4 a[220:223], v250, s[32:35], s99 offen offset:0 sc1
    buffer_load_dwordx4 a[224:227], v251, s[32:35], s99 offen offset:0 sc1
    buffer_load_dwordx4 a[236:239], v250, s[32:35], s99 offen offset:2048 sc1
    buffer_load_dwordx4 a[240:243], v251, s[32:35], s99 offen offset:2048 sc1
    buffer_load_dwordx2 v[136:137], v248, s[32:35], s99 offen offset:0 sc1
    buffer_load_dwordx2 v[138:139], v248, s[32:35], s99 offen offset:512 sc1
    buffer_load_dwordx2 v[140:141], v249, s[32:35], s99 offen offset:0 sc1
    buffer_load_dwordx2 v[142:143], v249, s[32:35], s99 offen offset:512 sc1
    s_waitcnt vmcnt(17)
    v_mfma_f32_16x16x32_bf16 v[40:43], a[140:143], a[228:231], v[40:43]
    v_mfma_f32_16x16x32_bf16 v[60:63], a[140:143], a[232:235], v[60:63]
    v_mfma_f32_16x16x32_bf16 v[44:47], a[144:147], a[228:231], v[44:47]
    v_mfma_f32_16x16x32_bf16 v[64:67], a[144:147], a[232:235], v[64:67]
    v_mfma_f32_16x16x32_bf16 v[48:51], a[148:151], a[228:231], v[48:51]
    v_mfma_f32_16x16x32_bf16 v[68:71], a[148:151], a[232:235], v[68:71]
    v_mfma_f32_16x16x32_bf16 v[52:55], a[152:155], a[228:231], v[52:55]
    v_mfma_f32_16x16x32_bf16 v[72:75], a[152:155], a[232:235], v[72:75]
    v_mfma_f32_16x16x32_bf16 v[56:59], a[156:159], a[228:231], v[56:59]
    v_mfma_f32_16x16x32_bf16 v[76:79], a[156:159], a[232:235], v[76:79]
    s_waitcnt vmcnt(13)
    v_mfma_f32_16x16x32_bf16 v[40:43], a[160:163], v[128:131], v[40:43]
    v_mfma_f32_16x16x32_bf16 v[60:63], a[160:163], v[132:135], v[60:63]
    v_mfma_f32_16x16x32_bf16 v[44:47], a[164:167], v[128:131], v[44:47]
    v_mfma_f32_16x16x32_bf16 v[64:67], a[164:167], v[132:135], v[64:67]
    v_mfma_f32_16x16x32_bf16 v[48:51], a[168:171], v[128:131], v[48:51]
    v_mfma_f32_16x16x32_bf16 v[68:71], a[168:171], v[132:135], v[68:71]
    v_mfma_f32_16x16x32_bf16 v[52:55], a[172:175], v[128:131], v[52:55]
    v_mfma_f32_16x16x32_bf16 v[72:75], a[172:175], v[132:135], v[72:75]
    v_mfma_f32_16x16x32_bf16 v[56:59], a[176:179], v[128:131], v[56:59]
    v_mfma_f32_16x16x32_bf16 v[76:79], a[176:179], v[132:135], v[76:79]
    ds_write_b128 v144, v[40:43] offset:0
    ds_write_b128 v144, v[60:63] offset:5120
    ds_write_b128 v144, v[44:47] offset:1024
    ds_write_b128 v144, v[64:67] offset:6144
    ds_write_b128 v144, v[48:51] offset:2048
    ds_write_b128 v144, v[68:71] offset:7168
    ds_write_b128 v144, v[52:55] offset:3072
    ds_write_b128 v144, v[72:75] offset:8192
    ds_write_b128 v144, v[56:59] offset:4096
    ds_write_b128 v144, v[76:79] offset:9216
    s_waitcnt vmcnt(10)
    v_mfma_f32_16x16x32_bf16 v[80:83], a[80:83], a[188:191], 0
    s_add_u32 s30, s58, 5120
    v_mfma_f32_16x16x32_bf16 v[100:103], a[80:83], a[192:195], 0
    buffer_load_dwordx4 v[152:155], v6, s[36:39], s30 offen offset:0 sc1
    v_mfma_f32_16x16x32_bf16 v[84:87], a[84:87], a[188:191], 0
    buffer_load_dwordx4 v[156:159], v6, s[36:39], s30 offen offset:1024 sc1
    v_mfma_f32_16x16x32_bf16 v[104:107], a[84:87], a[192:195], 0
    buffer_load_dwordx4 v[160:163], v6, s[36:39], s30 offen offset:2048 sc1
    v_mfma_f32_16x16x32_bf16 v[88:91], a[88:91], a[188:191], 0
    buffer_load_dwordx4 v[164:167], v6, s[36:39], s30 offen offset:3072 sc1
    v_mfma_f32_16x16x32_bf16 v[108:111], a[88:91], a[192:195], 0
    v_mfma_f32_16x16x32_bf16 v[92:95], a[92:95], a[188:191], 0
    v_mfma_f32_16x16x32_bf16 v[112:115], a[92:95], a[192:195], 0
    v_mfma_f32_16x16x32_bf16 v[96:99], a[96:99], a[188:191], 0
    v_mfma_f32_16x16x32_bf16 v[116:119], a[96:99], a[192:195], 0
    s_waitcnt vmcnt(12)
    v_mfma_f32_16x16x32_bf16 v[80:83], a[100:103], a[204:207], v[80:83]
    buffer_load_dwordx4 v[168:171], v7, s[36:39], s30 offen sc1
    v_mfma_f32_16x16x32_bf16 v[100:103], a[100:103], a[208:211], v[100:103]
    s_add_u32 s30, s58, 20480
    v_mfma_f32_16x16x32_bf16 v[84:87], a[104:107], a[204:207], v[84:87]
    buffer_load_dwordx4 v[172:175], v6, s[36:39], s30 offen offset:0 sc1
    v_mfma_f32_16x16x32_bf16 v[104:107], a[104:107], a[208:211], v[104:107]
    buffer_load_dwordx4 v[176:179], v6, s[36:39], s30 offen offset:1024 sc1
    v_mfma_f32_16x16x32_bf16 v[88:91], a[108:111], a[204:207], v[88:91]
    buffer_load_dwordx4 v[180:183], v6, s[36:39], s30 offen offset:2048 sc1
    v_mfma_f32_16x16x32_bf16 v[108:111], a[108:111], a[208:211], v[108:111]
    v_mfma_f32_16x16x32_bf16 v[92:95], a[112:115], a[204:207], v[92:95]
    v_mfma_f32_16x16x32_bf16 v[112:115], a[112:115], a[208:211], v[112:115]
    v_mfma_f32_16x16x32_bf16 v[96:99], a[116:119], a[204:207], v[96:99]
    v_mfma_f32_16x16x32_bf16 v[116:119], a[116:119], a[208:211], v[116:119]
    s_waitcnt vmcnt(14)
    v_mfma_f32_16x16x32_bf16 v[80:83], a[120:123], a[220:223], v[80:83]
    buffer_load_dwordx4 v[184:187], v6, s[36:39], s30 offen offset:3072 sc1
    v_mfma_f32_16x16x32_bf16 v[100:103], a[120:123], a[224:227], v[100:103]
    buffer_load_dwordx4 v[188:191], v7, s[36:39], s30 offen sc1
    v_mfma_f32_16x16x32_bf16 v[84:87], a[124:127], a[220:223], v[84:87]
    s_add_u32 s30, s58, 35840
    v_mfma_f32_16x16x32_bf16 v[104:107], a[124:127], a[224:227], v[104:107]
    buffer_load_dwordx4 v[192:195], v6, s[36:39], s30 offen offset:0 sc1
    v_mfma_f32_16x16x32_bf16 v[88:91], a[128:131], a[220:223], v[88:91]
    buffer_load_dwordx4 v[196:199], v6, s[36:39], s30 offen offset:1024 sc1
    v_mfma_f32_16x16x32_bf16 v[108:111], a[128:131], a[224:227], v[108:111]
    v_mfma_f32_16x16x32_bf16 v[92:95], a[132:135], a[220:223], v[92:95]
    v_mfma_f32_16x16x32_bf16 v[112:115], a[132:135], a[224:227], v[112:115]
    v_mfma_f32_16x16x32_bf16 v[96:99], a[136:139], a[220:223], v[96:99]
    v_mfma_f32_16x16x32_bf16 v[116:119], a[136:139], a[224:227], v[116:119]
    s_waitcnt vmcnt(16)
    v_mfma_f32_16x16x32_bf16 v[80:83], a[140:143], a[236:239], v[80:83]
    buffer_load_dwordx4 v[200:203], v6, s[36:39], s30 offen offset:2048 sc1
    v_mfma_f32_16x16x32_bf16 v[100:103], a[140:143], a[240:243], v[100:103]
    buffer_load_dwordx4 v[204:207], v6, s[36:39], s30 offen offset:3072 sc1
    v_mfma_f32_16x16x32_bf16 v[84:87], a[144:147], a[236:239], v[84:87]
    buffer_load_dwordx4 v[208:211], v7, s[36:39], s30 offen sc1
    v_mfma_f32_16x16x32_bf16 v[104:107], a[144:147], a[240:243], v[104:107]
    s_add_u32 s30, s58, 51200
    v_mfma_f32_16x16x32_bf16 v[88:91], a[148:151], a[236:239], v[88:91]
    buffer_load_dwordx4 v[212:215], v6, s[36:39], s30 offen offset:0 sc1
    v_mfma_f32_16x16x32_bf16 v[108:111], a[148:151], a[240:243], v[108:111]
    v_mfma_f32_16x16x32_bf16 v[92:95], a[152:155], a[236:239], v[92:95]
    v_mfma_f32_16x16x32_bf16 v[112:115], a[152:155], a[240:243], v[112:115]
    v_mfma_f32_16x16x32_bf16 v[96:99], a[156:159], a[236:239], v[96:99]
    v_mfma_f32_16x16x32_bf16 v[116:119], a[156:159], a[240:243], v[116:119]
    s_waitcnt vmcnt(16)
    v_mfma_f32_16x16x32_bf16 v[80:83], a[160:163], v[136:139], v[80:83]
    buffer_load_dwordx4 v[216:219], v6, s[36:39], s30 offen offset:1024 sc1
    v_mfma_f32_16x16x32_bf16 v[100:103], a[160:163], v[140:143], v[100:103]
    buffer_load_dwordx4 v[220:223], v6, s[36:39], s30 offen offset:2048 sc1
    v_mfma_f32_16x16x32_bf16 v[84:87], a[164:167], v[136:139], v[84:87]
    buffer_load_dwordx4 v[224:227], v6, s[36:39], s30 offen offset:3072 sc1
    v_mfma_f32_16x16x32_bf16 v[104:107], a[164:167], v[140:143], v[104:107]
    buffer_load_dwordx4 v[248:251], v7, s[36:39], s30 offen sc1
    v_mfma_f32_16x16x32_bf16 v[88:91], a[168:171], v[136:139], v[88:91]
    v_mfma_f32_16x16x32_bf16 v[108:111], a[168:171], v[140:143], v[108:111]
    v_mfma_f32_16x16x32_bf16 v[92:95], a[172:175], v[136:139], v[92:95]
    v_mfma_f32_16x16x32_bf16 v[112:115], a[172:175], v[140:143], v[112:115]
    v_mfma_f32_16x16x32_bf16 v[96:99], a[176:179], v[136:139], v[96:99]
    v_mfma_f32_16x16x32_bf16 v[116:119], a[176:179], v[140:143], v[116:119]
    ds_write_b128 v144, v[80:83] offset:10240
    ds_write_b128 v144, v[100:103] offset:15360
    ds_write_b128 v144, v[84:87] offset:11264
    ds_write_b128 v144, v[104:107] offset:16384
    ds_write_b128 v144, v[88:91] offset:12288
    ds_write_b128 v144, v[108:111] offset:17408
    ds_write_b128 v144, v[92:95] offset:13312
    ds_write_b128 v144, v[112:115] offset:18432
    ds_write_b128 v144, v[96:99] offset:14336
    ds_write_b128 v144, v[116:119] offset:19456
    s_waitcnt lgkmcnt(0)
    s_barrier
    ds_read_b128 v[40:43], v10 offset:0
    ds_read_b128 v[60:63], v11 offset:0
    ds_read_b128 v[80:83], v12 offset:0
    ds_read_b128 v[100:103], v13 offset:0
    ds_read_b128 v[44:47], v10 offset:1024
    ds_read_b128 v[64:67], v11 offset:1024
    ds_read_b128 v[84:87], v12 offset:1024
    ds_read_b128 v[104:107], v13 offset:1024
    ds_read_b128 v[48:51], v10 offset:2048
    ds_read_b128 v[68:71], v11 offset:2048
    ds_read_b128 v[88:91], v12 offset:2048
    ds_read_b128 v[108:111], v13 offset:2048
    ds_read_b128 v[52:55], v10 offset:3072
    ds_read_b128 v[72:75], v11 offset:3072
    ds_read_b128 v[92:95], v12 offset:3072
    ds_read_b128 v[112:115], v13 offset:3072
    ds_read_b128 v[56:59], v10 offset:4096
    ds_read_b128 v[76:79], v11 offset:4096
    ds_read_b128 v[96:99], v12 offset:4096
    ds_read_b128 v[116:119], v13 offset:4096
    s_waitcnt lgkmcnt(15)
    v_pk_add_f32 v[40:41], v[40:41], v[20:21]
    v_pk_add_f32 v[42:43], v[42:43], v[22:23]
    v_pk_add_f32 v[40:41], v[40:41], v[60:61]
    v_pk_add_f32 v[80:81], v[80:81], v[100:101]
    v_pk_add_f32 v[42:43], v[42:43], v[62:63]
    v_pk_add_f32 v[82:83], v[82:83], v[102:103]
    v_pk_add_f32 v[40:41], v[40:41], v[80:81]
    v_pk_add_f32 v[42:43], v[42:43], v[82:83]
    v_cvt_pk_bf16_f32 v228, v40, v41
    v_cvt_pk_bf16_f32 v229, v42, v43
    buffer_store_dwordx2 v[228:229], v243, s[44:47], 0 offen offset:0 sc1
    s_waitcnt lgkmcnt(12)
    v_pk_add_f32 v[44:45], v[44:45], v[24:25]
    v_pk_add_f32 v[46:47], v[46:47], v[26:27]
    v_pk_add_f32 v[44:45], v[44:45], v[64:65]
    v_pk_add_f32 v[84:85], v[84:85], v[104:105]
    v_pk_add_f32 v[46:47], v[46:47], v[66:67]
    v_pk_add_f32 v[86:87], v[86:87], v[106:107]
    v_pk_add_f32 v[44:45], v[44:45], v[84:85]
    v_pk_add_f32 v[46:47], v[46:47], v[86:87]
    v_cvt_pk_bf16_f32 v230, v44, v45
    v_cvt_pk_bf16_f32 v231, v46, v47
    buffer_store_dwordx2 v[230:231], v243, s[44:47], 0 offen offset:1024 sc1
    s_waitcnt lgkmcnt(8)
    v_pk_add_f32 v[48:49], v[48:49], v[28:29]
    v_pk_add_f32 v[50:51], v[50:51], v[30:31]
    v_pk_add_f32 v[48:49], v[48:49], v[68:69]
    v_pk_add_f32 v[88:89], v[88:89], v[108:109]
    v_pk_add_f32 v[50:51], v[50:51], v[70:71]
    v_pk_add_f32 v[90:91], v[90:91], v[110:111]
    v_pk_add_f32 v[48:49], v[48:49], v[88:89]
    v_pk_add_f32 v[50:51], v[50:51], v[90:91]
    v_cvt_pk_bf16_f32 v232, v48, v49
    v_cvt_pk_bf16_f32 v233, v50, v51
    buffer_store_dwordx2 v[232:233], v243, s[44:47], 0 offen offset:2048 sc1
    s_waitcnt lgkmcnt(4)
    v_pk_add_f32 v[52:53], v[52:53], v[32:33]
    v_pk_add_f32 v[54:55], v[54:55], v[34:35]
    v_pk_add_f32 v[52:53], v[52:53], v[72:73]
    v_pk_add_f32 v[92:93], v[92:93], v[112:113]
    v_pk_add_f32 v[54:55], v[54:55], v[74:75]
    v_pk_add_f32 v[94:95], v[94:95], v[114:115]
    v_pk_add_f32 v[52:53], v[52:53], v[92:93]
    v_pk_add_f32 v[54:55], v[54:55], v[94:95]
    v_cvt_pk_bf16_f32 v234, v52, v53
    v_cvt_pk_bf16_f32 v235, v54, v55
    buffer_store_dwordx2 v[234:235], v243, s[44:47], 0 offen offset:3072 sc1
    s_waitcnt lgkmcnt(0)
    v_pk_add_f32 v[56:57], v[56:57], v[36:37]
    v_pk_add_f32 v[58:59], v[58:59], v[38:39]
    v_pk_add_f32 v[56:57], v[56:57], v[76:77]
    v_pk_add_f32 v[96:97], v[96:97], v[116:117]
    v_pk_add_f32 v[58:59], v[58:59], v[78:79]
    v_pk_add_f32 v[98:99], v[98:99], v[118:119]
    v_pk_add_f32 v[56:57], v[56:57], v[96:97]
    v_pk_add_f32 v[58:59], v[58:59], v[98:99]
    v_cvt_pk_bf16_f32 v236, v56, v57
    v_cvt_pk_bf16_f32 v237, v58, v59
    buffer_store_dwordx2 v[236:237], v243, s[44:47], s55 offen sc1
    v_lshlrev_b32 v40, 16, v228
    v_and_b32 v41, s52, v228
    v_lshlrev_b32 v42, 16, v229
    v_and_b32 v43, s52, v229
    v_pk_mul_f32 v[122:123], v[40:41], v[40:41]
    v_pk_add_f32 v[120:121], v[40:41], v[42:43]
    v_pk_fma_f32 v[122:123], v[42:43], v[42:43], v[122:123]
    v_lshlrev_b32 v44, 16, v230
    v_and_b32 v45, s52, v230
    v_lshlrev_b32 v46, 16, v231
    v_and_b32 v47, s52, v231
    v_pk_add_f32 v[120:121], v[120:121], v[44:45]
    v_pk_fma_f32 v[122:123], v[44:45], v[44:45], v[122:123]
    v_pk_add_f32 v[120:121], v[120:121], v[46:47]
    v_pk_fma_f32 v[122:123], v[46:47], v[46:47], v[122:123]
    v_lshlrev_b32 v48, 16, v232
    v_and_b32 v49, s52, v232
    v_lshlrev_b32 v50, 16, v233
    v_and_b32 v51, s52, v233
    v_pk_add_f32 v[120:121], v[120:121], v[48:49]
    v_pk_fma_f32 v[122:123], v[48:49], v[48:49], v[122:123]
    v_pk_add_f32 v[120:121], v[120:121], v[50:51]
    v_pk_fma_f32 v[122:123], v[50:51], v[50:51], v[122:123]
    v_lshlrev_b32 v52, 16, v234
    v_and_b32 v53, s52, v234
    v_lshlrev_b32 v54, 16, v235
    v_and_b32 v55, s52, v235
    v_pk_add_f32 v[120:121], v[120:121], v[52:53]
    v_pk_fma_f32 v[122:123], v[52:53], v[52:53], v[122:123]
    v_pk_add_f32 v[120:121], v[120:121], v[54:55]
    v_pk_fma_f32 v[122:123], v[54:55], v[54:55], v[122:123]
    v_lshlrev_b32 v56, 16, v236
    v_and_b32 v57, s52, v236
    v_lshlrev_b32 v58, 16, v237
    v_and_b32 v59, s52, v237
    v_pk_add_f32 v[120:121], v[120:121], v[56:57]
    v_pk_fma_f32 v[122:123], v[56:57], v[56:57], v[122:123]
    v_pk_add_f32 v[120:121], v[120:121], v[58:59]
    v_pk_fma_f32 v[122:123], v[58:59], v[58:59], v[122:123]
    v_add_f32 v120, v120, v121
    v_add_f32 v121, v122, v123
    s_lshl_b32 s27, s25, 6
    s_lshl_b32 s28, s24, 4
    s_add_u32 s27, s27, s28
    s_lshl_b32 s27, s27, 3
    s_lshl_b32 s28, s26, 14
    s_add_u32 s27, s27, s28
    v_mov_b32 v124, v120
    v_mov_b32 v125, v121
    s_nop 0
    v_permlane32_swap_b32 v120, v124
    v_permlane32_swap_b32 v121, v125
    v_pk_add_f32 v[120:121], v[120:121], v[124:125]
    v_mov_b32 v124, v120
    v_mov_b32 v125, v121
    s_nop 0
    v_permlane16_swap_b32 v120, v124
    v_permlane16_swap_b32 v121, v125
    v_pk_add_f32 v[120:121], v[120:121], v[124:125]
    v_lshlrev_b32 v2, 3, v1
    v_lshrrev_b32 v3, 4, v1
    v_lshl_add_u32 v2, v3, 28, v2
    buffer_store_dwordx2 v[120:121], v2, s[48:51], s27 offen sc1
    s_add_u32 s32, s22, 0xb00000
    s_addc_u32 s33, s23, 0
    s_mov_b32 s34, 0x280000
    s_mov_b32 s35, 0x00020000
    s_add_u32 s44, s22, 0xe00000
    s_addc_u32 s45, s23, 0
    s_mov_b32 s46, 0x600000
    s_mov_b32 s47, 0x00020000
    v_lshrrev_b32 v3, 5, v1
    v_and_b32 v2, 31, v1
    v_lshlrev_b32 v4, 3, v2
    v_lshl_add_u32 v4, v3, 16, v4
    v_add_u32 v10, 61440, v6
    v_add_u32 v11, 122880, v6
    v_and_b32 v13, 0xffff0000, v145
    v_sub_f32 v13, v145, v13
    v_and_b32 v14, 0xffff0000, v13
    v_sub_f32 v14, v13, v14
    v_perm_b32 v32, v13, v145, s61
    v_lshrrev_b32 v33, 16, v14
    v_mov_b32 v34, 0
    v_mov_b32 v35, 0
    v_mov_b32 v36, v32
    v_mov_b32 v37, v33
    v_mov_b32 v38, 0
    v_mov_b32 v39, 0
    v_permlane32_swap_b32 v32, v36
    v_permlane32_swap_b32 v33, v37
    v_and_b32 v13, 0xffff0000, v146
    v_sub_f32 v13, v146, v13
    v_and_b32 v14, 0xffff0000, v13
    v_sub_f32 v14, v13, v14
    v_perm_b32 v40, v13, v146, s61
    v_lshrrev_b32 v41, 16, v14
    v_mov_b32 v42, 0
    v_mov_b32 v43, 0
    v_mov_b32 v44, v40
    v_mov_b32 v45, v41
    v_mov_b32 v46, 0
    v_mov_b32 v47, 0
    v_permlane32_swap_b32 v40, v44
    v_permlane32_swap_b32 v41, v45
    v_and_b32 v13, 0xffff0000, v147
    v_sub_f32 v13, v147, v13
    v_and_b32 v14, 0xffff0000, v13
    v_sub_f32 v14, v13, v14
    v_perm_b32 v48, v13, v147, s61
    v_lshrrev_b32 v49, 16, v14
    v_mov_b32 v50, 0
    v_mov_b32 v51, 0
    v_mov_b32 v52, v48
    v_mov_b32 v53, v49
    v_mov_b32 v54, 0
    v_mov_b32 v55, 0
    v_permlane32_swap_b32 v48, v52
    v_permlane32_swap_b32 v49, v53
    s_mul_i32 s27, s54, 96
    s_mul_i32 s28, s53, 6
    s_add_u32 s27, s27, s28
    s_lshl_b32 s4, s27, 10
    s_lshr_b32 s27, s54, 1
    s_lshl_b32 s27, s27, 2
    s_lshr_b32 s28, s53, 2
    s_add_u32 s27, s27, s28
    s_mul_i32 s27, s27, 384
    s_add_u32 s5, s27, 8192
    s_lshl_b32 s27, s25, 2
    s_add_u32 s27, s27, s24
    s_mul_i32 s27, s27, 384
    s_add_u32 s6, s27, 8192
    s_add_u32 s40, s22, 0xe00000
    s_addc_u32 s41, s23, 0
    s_mov_b32 s42, 0x600000
    s_mov_b32 s43, 0x00020000
    s_xor_b32 s28, s63, 1
    s_mul_i32 s56, s63, 98304
    s_mul_i32 s57, s28, 98304
    s_mul_i32 s27, s24, 24576
    s_add_u32 s56, s56, s27
    s_add_u32 s57, s57, s27
    s_lshl_b32 s27, s63, 7
    s_waitcnt vmcnt(0)
    s_mov_b64 exec, 1
    buffer_atomic_add v9, v8, s[8:11], s27 offen sc1
    s_mov_b64 exec, -1
    s_barrier
    ds_read_b128 v[56:59], v10 offset:20480
    ds_read_b128 v[60:63], v10 offset:21504
    ds_read_b128 v[64:67], v10 offset:22528
    ds_read_b128 v[68:71], v10 offset:23552
    ds_read_b128 v[72:75], v10 offset:24576
    ds_read_b128 v[76:79], v10 offset:25600
    s_add_u32 m0, s59, 0
    s_nop 0
    buffer_load_dwordx4 v6, s[12:15], s16 offen offset:0 sc1 lds
    buffer_load_dwordx4 v6, s[12:15], s16 offen offset:1024 sc1 lds
    buffer_load_dwordx4 v6, s[12:15], s16 offen offset:2048 sc1 lds
    buffer_load_dwordx4 v6, s[12:15], s16 offen offset:3072 sc1 lds
    s_add_u32 m0, s59, 4096
    s_nop 0
    buffer_load_dwordx4 v7, s[12:15], s16 offen offset:0 sc1 lds
    s_add_u32 s16, s16, 20480
    s_lshl_b32 s27, s54, 7
    s_mov_b32 s62, 0x40000
    s_mov_b64 exec, 1
L_poll_p4:
    v_mov_b32 v2, 0
    buffer_atomic_add v2, v8, s[8:11], s27 offen sc0 sc1
    s_sub_u32 s62, s62, 1
    s_cmp_eq_u32 s62, 0
    s_cbranch_scc1 L_polled_p4
    s_waitcnt vmcnt(0)
    v_readfirstlane_b32 s28, v2
    s_nop 1
    s_cmp_lt_u32 s28, 16
    s_cbranch_scc1 L_poll_p4
L_polled_p4:
    s_waitcnt vmcnt(0)
    s_mov_b64 exec, -1
    buffer_load_dwordx4 a[96:99], v6, s[32:35], s60 offen offset:0 sc1
    buffer_load_dwordx4 a[100:103], v6, s[32:35], s60 offen offset:1024 sc1
    buffer_load_dwordx4 a[104:107], v6, s[32:35], s60 offen offset:2048 sc1
    buffer_load_dwordx4 a[108:111], v6, s[32:35], s60 offen offset:3072 sc1
    s_add_u32 s60, s60, 4096
    buffer_load_dwordx4 a[112:115], v6, s[32:35], s60 offen offset:0 sc1
    buffer_load_dwordx4 a[116:119], v6, s[32:35], s60 offen offset:1024 sc1
    buffer_load_dwordx4 a[120:123], v6, s[32:35], s60 offen offset:2048 sc1
    buffer_load_dwordx4 a[124:127], v6, s[32:35], s60 offen offset:3072 sc1
    s_add_u32 s60, s60, 4096
    buffer_load_dwordx4 a[128:131], v6, s[32:35], s60 offen offset:0 sc1
    buffer_load_dwordx4 a[132:135], v6, s[32:35], s60 offen offset:1024 sc1
    buffer_load_dwordx4 a[136:139], v6, s[32:35], s60 offen offset:2048 sc1
    buffer_load_dwordx4 a[140:143], v6, s[32:35], s60 offen offset:3072 sc1
    s_add_u32 s60, s60, 4096
    s_waitcnt vmcnt(11) lgkmcnt(4)
    v_mfma_f32_32x32x16_bf16 v[88:103], v[56:59], a[96:99], 0
    ds_read_b128 v[80:83], v10 offset:26624
    ds_read_b128 v[84:87], v10 offset:27648
    v_mfma_f32_32x32x16_bf16 v[104:119], v[60:63], a[96:99], 0
    buffer_load_dwordx4 a[144:147], v6, s[32:35], s60 offen offset:0 sc1
    s_waitcnt vmcnt(11) lgkmcnt(4)
    v_mfma_f32_32x32x16_bf16 v[88:103], v[64:67], a[100:103], v[88:103]
    ds_read_b128 v[56:59], v10 offset:28672
    ds_read_b128 v[60:63], v10 offset:29696
    v_mfma_f32_32x32x16_bf16 v[104:119], v[68:71], a[100:103], v[104:119]
    buffer_load_dwordx4 a[148:151], v6, s[32:35], s60 offen offset:1024 sc1
    s_waitcnt vmcnt(11) lgkmcnt(4)
    v_mfma_f32_32x32x16_bf16 v[88:103], v[72:75], a[104:107], v[88:103]
    ds_read_b128 v[64:67], v10 offset:30720
    ds_read_b128 v[68:71], v10 offset:31744
    v_mfma_f32_32x32x16_bf16 v[104:119], v[76:79], a[104:107], v[104:119]
    buffer_load_dwordx4 a[152:155], v6, s[32:35], s60 offen offset:2048 sc1
    s_waitcnt vmcnt(11) lgkmcnt(4)
    v_mfma_f32_32x32x16_bf16 v[88:103], v[80:83], a[108:111], v[88:103]
    ds_read_b128 v[72:75], v10 offset:32768
    ds_read_b128 v[76:79], v10 offset:33792
    buffer_load_dwordx4 a[156:159], v6, s[32:35], s60 offen offset:3072 sc1
    v_mfma_f32_32x32x16_bf16 v[104:119], v[84:87], a[108:111], v[104:119]
    s_add_u32 s60, s60, 4096
    s_waitcnt vmcnt(11) lgkmcnt(4)
    v_mfma_f32_32x32x16_bf16 v[88:103], v[56:59], a[112:115], v[88:103]
    ds_read_b128 v[80:83], v10 offset:34816
    ds_read_b128 v[84:87], v10 offset:35840
    buffer_load_dwordx4 a[160:163], v6, s[32:35], s60 offen offset:0 sc1
    s_lshl_b32 s7, s54, 8
    buffer_load_dwordx2 v[16:17], v4, s[48:51], s7 offen sc1
    v_mfma_f32_32x32x16_bf16 v[104:119], v[60:63], a[112:115], v[104:119]
    s_add_u32 s7, s7, 16384
    buffer_load_dwordx2 v[18:19], v4, s[48:51], s7 offen sc1
    s_add_u32 s7, s7, 16384
    buffer_load_dwordx2 v[20:21], v4, s[48:51], s7 offen sc1
    s_add_u32 s7, s7, 16384
    buffer_load_dwordx2 v[22:23], v4, s[48:51], s7 offen sc1
    s_add_u32 s7, s7, 16384
    s_waitcnt vmcnt(15) lgkmcnt(4)
    v_mfma_f32_32x32x16_bf16 v[88:103], v[64:67], a[116:119], v[88:103]
    ds_read_b128 v[56:59], v10 offset:36864
    ds_read_b128 v[60:63], v10 offset:37888
    v_mfma_f32_32x32x16_bf16 v[104:119], v[68:71], a[116:119], v[104:119]
    buffer_load_dwordx4 a[164:167], v6, s[32:35], s60 offen offset:1024 sc1
    s_waitcnt vmcnt(15) lgkmcnt(4)
    v_mfma_f32_32x32x16_bf16 v[88:103], v[72:75], a[120:123], v[88:103]
    ds_read_b128 v[64:67], v10 offset:38912
    ds_read_b128 v[68:71], v10 offset:39936
    v_mfma_f32_32x32x16_bf16 v[104:119], v[76:79], a[120:123], v[104:119]
    buffer_load_dwordx4 a[168:171], v6, s[32:35], s60 offen offset:2048 sc1
    s_waitcnt vmcnt(15) lgkmcnt(4)
    s_barrier
    v_mfma_f32_32x32x16_bf16 v[88:103], v[80:83], a[124:127], v[88:103]
    ds_read_b128 v[72:75], v10 offset:40960
    ds_read_b128 v[76:79], v10 offset:41984
    buffer_load_dwordx4 a[172:175], v6, s[32:35], s60 offen offset:3072 sc1
    v_mfma_f32_32x32x16_bf16 v[104:119], v[84:87], a[124:127], v[104:119]
    s_add_u32 s60, s60, 4096
    s_waitcnt vmcnt(15) lgkmcnt(4)
    v_mfma_f32_32x32x16_bf16 v[88:103], v[56:59], a[128:131], v[88:103]
    ds_read_b128 v[80:83], v10 offset:43008
    ds_read_b128 v[84:87], v10 offset:44032
    v_mfma_f32_32x32x16_bf16 v[104:119], v[60:63], a[128:131], v[104:119]
    buffer_load_dwordx4 a[176:179], v6, s[32:35], s60 offen offset:0 sc1
    s_waitcnt vmcnt(15) lgkmcnt(4)
    v_mfma_f32_32x32x16_bf16 v[88:103], v[64:67], a[132:135], v[88:103]
    ds_read_b128 v[56:59], v10 offset:45056
    ds_read_b128 v[60:63], v10 offset:46080
    v_mfma_f32_32x32x16_bf16 v[104:119], v[68:71], a[132:135], v[104:119]
    buffer_load_dwordx4 a[180:183], v6, s[32:35], s60 offen offset:1024 sc1
    s_waitcnt vmcnt(15) lgkmcnt(4)
    v_mfma_f32_32x32x16_bf16 v[88:103], v[72:75], a[136:139], v[88:103]
    ds_read_b128 v[64:67], v10 offset:47104
    ds_read_b128 v[68:71], v10 offset:48128
    v_mfma_f32_32x32x16_bf16 v[104:119], v[76:79], a[136:139], v[104:119]
    buffer_load_dwordx4 a[184:187], v6, s[32:35], s60 offen offset:2048 sc1
    s_waitcnt vmcnt(15) lgkmcnt(4)
    v_mfma_f32_32x32x16_bf16 v[88:103], v[80:83], a[140:143], v[88:103]
    ds_read_b128 v[72:75], v10 offset:49152
    ds_read_b128 v[76:79], v10 offset:50176
    buffer_load_dwordx4 a[188:191], v6, s[32:35], s60 offen offset:3072 sc1
    v_mfma_f32_32x32x16_bf16 v[104:119], v[84:87], a[140:143], v[104:119]
    s_add_u32 s60, s60, 4096
    s_waitcnt vmcnt(15) lgkmcnt(4)
    v_mfma_f32_32x32x16_bf16 v[88:103], v[56:59], a[144:147], v[88:103]
    ds_read_b128 v[80:83], v10 offset:51200
    ds_read_b128 v[84:87], v10 offset:52224
    v_mfma_f32_32x32x16_bf16 v[104:119], v[60:63], a[144:147], v[104:119]
    buffer_load_dwordx4 a[192:195], v6, s[32:35], s60 offen offset:0 sc1
    s_waitcnt vmcnt(15) lgkmcnt(4)
    v_mfma_f32_32x32x16_bf16 v[88:103], v[64:67], a[148:151], v[88:103]
    ds_read_b128 v[56:59], v10 offset:53248
    ds_read_b128 v[60:63], v10 offset:54272
    v_mfma_f32_32x32x16_bf16 v[104:119], v[68:71], a[148:151], v[104:119]
    buffer_load_dwordx4 a[196:199], v6, s[32:35], s60 offen offset:1024 sc1
    s_waitcnt vmcnt(15) lgkmcnt(4)
    v_mfma_f32_32x32x16_bf16 v[88:103], v[72:75], a[152:155], v[88:103]
    ds_read_b128 v[64:67], v10 offset:55296
    ds_read_b128 v[68:71], v10 offset:56320
    v_mfma_f32_32x32x16_bf16 v[104:119], v[76:79], a[152:155], v[104:119]
    buffer_load_dwordx4 a[200:203], v6, s[32:35], s60 offen offset:2048 sc1
    s_waitcnt vmcnt(15) lgkmcnt(4)
    v_mfma_f32_32x32x16_bf16 v[88:103], v[80:83], a[156:159], v[88:103]
    ds_read_b128 v[72:75], v10 offset:57344
    ds_read_b128 v[76:79], v10 offset:58368
    buffer_load_dwordx4 a[204:207], v6, s[32:35], s60 offen offset:3072 sc1
    v_mfma_f32_32x32x16_bf16 v[104:119], v[84:87], a[156:159], v[104:119]
    s_add_u32 s60, s60, 4096
    s_waitcnt vmcnt(15) lgkmcnt(4)
    v_mfma_f32_32x32x16_bf16 v[88:103], v[56:59], a[160:163], v[88:103]
    ds_read_b128 v[80:83], v10 offset:59392
    ds_read_b128 v[84:87], v10 offset:60416
    v_mfma_f32_32x32x16_bf16 v[104:119], v[60:63], a[160:163], v[104:119]
    buffer_load_dwordx4 a[208:211], v6, s[32:35], s60 offen offset:0 sc1
    s_waitcnt vmcnt(11) lgkmcnt(4)
    s_barrier
    v_mfma_f32_32x32x16_bf16 v[88:103], v[64:67], a[164:167], v[88:103]
    ds_read_b128 v[56:59], v11 offset:0
    ds_read_b128 v[60:63], v11 offset:1024
    v_mfma_f32_32x32x16_bf16 v[104:119], v[68:71], a[164:167], v[104:119]
    buffer_load_dwordx4 a[212:215], v6, s[32:35], s60 offen offset:1024 sc1
    s_waitcnt vmcnt(11) lgkmcnt(4)
    v_mfma_f32_32x32x16_bf16 v[88:103], v[72:75], a[168:171], v[88:103]
    ds_read_b128 v[64:67], v11 offset:2048
    ds_read_b128 v[68:71], v11 offset:3072
    v_mfma_f32_32x32x16_bf16 v[104:119], v[76:79], a[168:171], v[104:119]
    buffer_load_dwordx4 a[216:219], v6, s[32:35], s60 offen offset:2048 sc1
    s_waitcnt vmcnt(11) lgkmcnt(4)
    v_mfma_f32_32x32x16_bf16 v[88:103], v[80:83], a[172:175], v[88:103]
    ds_read_b128 v[72:75], v11 offset:4096
    ds_read_b128 v[76:79], v11 offset:5120
    buffer_load_dwordx4 a[220:223], v6, s[32:35], s60 offen offset:3072 sc1
    v_mfma_f32_32x32x16_bf16 v[104:119], v[84:87], a[172:175], v[104:119]
    s_add_u32 s60, s60, 4096
    s_waitcnt vmcnt(11) lgkmcnt(4)
    v_mfma_f32_32x32x16_bf16 v[88:103], v[56:59], a[176:179], v[88:103]
    ds_read_b128 v[80:83], v11 offset:6144
    ds_read_b128 v[84:87], v11 offset:7168
    v_mfma_f32_32x32x16_bf16 v[104:119], v[60:63], a[176:179], v[104:119]
    buffer_load_dwordx4 a[224:227], v6, s[32:35], s60 offen offset:0 sc1
    s_waitcnt vmcnt(11) lgkmcnt(4)
    v_mfma_f32_32x32x16_bf16 v[88:103], v[64:67], a[180:183], v[88:103]
    ds_read_b128 v[56:59], v11 offset:8192
    ds_read_b128 v[60:63], v11 offset:9216
    v_mfma_f32_32x32x16_bf16 v[104:119], v[68:71], a[180:183], v[104:119]
    buffer_load_dwordx4 a[228:231], v6, s[32:35], s60 offen offset:1024 sc1
    s_waitcnt vmcnt(11) lgkmcnt(4)
    v_mfma_f32_32x32x16_bf16 v[88:103], v[72:75], a[184:187], v[88:103]
    ds_read_b128 v[64:67], v11 offset:10240
    ds_read_b128 v[68:71], v11 offset:11264
    v_mfma_f32_32x32x16_bf16 v[104:119], v[76:79], a[184:187], v[104:119]
    buffer_load_dwordx4 a[232:235], v6, s[32:35], s60 offen offset:2048 sc1
    s_waitcnt vmcnt(11) lgkmcnt(4)
    v_mfma_f32_32x32x16_bf16 v[88:103], v[80:83], a[188:191], v[88:103]
    ds_read_b128 v[72:75], v11 offset:12288
    ds_read_b128 v[76:79], v11 offset:13312
    buffer_load_dwordx4 a[236:239], v6, s[32:35], s60 offen offset:3072 sc1
    v_mfma_f32_32x32x16_bf16 v[104:119], v[84:87], a[188:191], v[104:119]
    s_add_u32 s60, s60, 4096
    s_waitcnt vmcnt(11) lgkmcnt(4)
    v_mfma_f32_32x32x16_bf16 v[88:103], v[56:59], a[192:195], v[88:103]
    ds_read_b128 v[80:83], v11 offset:14336
    ds_read_b128 v[84:87], v11 offset:15360
    buffer_load_dwordx4 a[240:243], v6, s[32:35], s60 offen offset:0 sc1
    v_mfma_f32_32x32x16_bf16 v[104:119], v[60:63], a[192:195], v[104:119]
    s_add_u32 m0, s59, 20480
    s_nop 0
    buffer_load_dwordx4 v6, s[12:15], s16 offen offset:0 sc1 lds
    s_waitcnt vmcnt(12) lgkmcnt(4)
    v_mfma_f32_32x32x16_bf16 v[88:103], v[64:67], a[196:199], v[88:103]
    ds_read_b128 v[56:59], v11 offset:16384
    ds_read_b128 v[60:63], v11 offset:17408
    buffer_load_dwordx4 a[244:247], v6, s[32:35], s60 offen offset:1024 sc1
    v_mfma_f32_32x32x16_bf16 v[104:119], v[68:71], a[196:199], v[104:119]
    buffer_load_dwordx4 v6, s[12:15], s16 offen offset:1024 sc1 lds
    buffer_load_dwordx4 v6, s[12:15], s16 offen offset:2048 sc1 lds
    s_waitcnt vmcnt(14) lgkmcnt(4)
    v_mfma_f32_32x32x16_bf16 v[88:103], v[72:75], a[200:203], v[88:103]
    ds_read_b128 v[64:67], v11 offset:18432
    ds_read_b128 v[68:71], v11 offset:19456
    buffer_load_dwordx4 a[248:251], v6, s[32:35], s60 offen offset:2048 sc1
    s_waitcnt vmcnt(25)
    v_mfma_f32_32x32x16_bf16 v[104:119], v[76:79], a[200:203], v[104:119]
    v_add_f32 v16, v16, v18
    v_add_f32 v17, v17, v19
    buffer_load_dwordx4 v6, s[12:15], s16 offen offset:3072 sc1 lds
    s_add_u32 m0, s59, 24576
    s_waitcnt vmcnt(15) lgkmcnt(4)
    s_barrier
    v_mfma_f32_32x32x16_bf16 v[88:103], v[80:83], a[204:207], v[88:103]
    ds_read_b128 v[72:75], v11 offset:20480
    ds_read_b128 v[76:79], v11 offset:21504
    buffer_load_dwordx4 a[252:255], v6, s[32:35], s60 offen offset:3072 sc1
    s_add_u32 s60, s60, 4096
    v_mfma_f32_32x32x16_bf16 v[104:119], v[84:87], a[204:207], v[104:119]
    v_add_f32 v20, v20, v22
    v_add_f32 v21, v21, v23
    v_add_f32 v16, v16, v20
    buffer_load_dwordx4 v7, s[12:15], s16 offen offset:0 sc1 lds
    s_add_u32 s16, s16, 20480
    s_waitcnt vmcnt(16) lgkmcnt(4)
    v_mfma_f32_32x32x16_bf16 v[88:103], v[56:59], a[208:211], v[88:103]
    ds_read_b128 v[80:83], v11 offset:22528
    ds_read_b128 v[84:87], v11 offset:23552
    v_add_f32 v17, v17, v21
    v_mfma_f32_32x32x16_bf16 v[104:119], v[60:63], a[208:211], v[104:119]
    v_mov_b32 v18, v16
    v_mov_b32 v19, v17
    s_waitcnt vmcnt(15) lgkmcnt(4)
    v_mfma_f32_32x32x16_bf16 v[88:103], v[64:67], a[212:215], v[88:103]
    ds_read_b128 v[56:59], v11 offset:24576
    ds_read_b128 v[60:63], v11 offset:25600
    v_cmp_gt_u32 vcc, 32, v1
    v_mov_b32 v30, 0
    v_mfma_f32_32x32x16_bf16 v[104:119], v[68:71], a[212:215], v[104:119]
    v_mov_b32 v31, 0
    s_add_u32 m0, s59, 40960
    s_nop 0
    buffer_load_dwordx4 v6, s[12:15], s16 offen offset:0 sc1 lds
    s_waitcnt vmcnt(15) lgkmcnt(4)
    v_mfma_f32_32x32x16_bf16 v[88:103], v[72:75], a[216:219], v[88:103]
    ds_read_b128 v[64:67], v11 offset:26624
    ds_read_b128 v[68:71], v11 offset:27648
    v_permlane32_swap_b32 v16, v18
    v_permlane32_swap_b32 v17, v19
    v_mfma_f32_32x32x16_bf16 v[104:119], v[76:79], a[216:219], v[104:119]
    v_add_f32 v16, v16, v18
    buffer_load_dwordx4 v6, s[12:15], s16 offen offset:1024 sc1 lds
    buffer_load_dwordx4 v6, s[12:15], s16 offen offset:2048 sc1 lds
    s_waitcnt vmcnt(16) lgkmcnt(4)
    v_mfma_f32_32x32x16_bf16 v[88:103], v[80:83], a[220:223], v[88:103]
    ds_read_b128 v[72:75], v11 offset:28672
    ds_read_b128 v[76:79], v11 offset:29696
    v_add_f32 v17, v17, v19
    v_mul_f32 v16, 0x3acccccd, v16
    v_mfma_f32_32x32x16_bf16 v[104:119], v[84:87], a[220:223], v[104:119]
    v_mul_f32 v17, 0x3acccccd, v17
    buffer_load_dwordx4 v6, s[12:15], s16 offen offset:3072 sc1 lds
    s_add_u32 m0, s59, 45056
    s_waitcnt vmcnt(16) lgkmcnt(4)
    v_mfma_f32_32x32x16_bf16 v[88:103], v[56:59], a[224:227], v[88:103]
    ds_read_b128 v[80:83], v11 offset:30720
    ds_read_b128 v[84:87], v11 offset:31744
    v_fma_f32 v17, -v16, v16, v17
    v_max_f32 v17, 0, v17
    v_mfma_f32_32x32x16_bf16 v[104:119], v[60:63], a[224:227], v[104:119]
    v_cvt_pk_bf16_f32 v2, v16, v16
    buffer_load_dwordx4 v7, s[12:15], s16 offen offset:0 sc1 lds
    s_add_u32 s16, s16, 20480
    s_waitcnt vmcnt(16) lgkmcnt(4)
    v_mfma_f32_32x32x16_bf16 v[88:103], v[64:67], a[228:231], v[88:103]
    ds_read_b128 v[56:59], v11 offset:32768
    ds_read_b128 v[60:63], v11 offset:33792
    v_lshlrev_b32 v2, 16, v2
    v_mfma_f32_32x32x16_bf16 v[104:119], v[68:71], a[228:231], v[104:119]
    v_xor_b32 v24, 0x80000000, v2
    v_cvt_pk_bf16_f32 v17, v17, v17
    s_waitcnt vmcnt(15) lgkmcnt(4)
    v_mfma_f32_32x32x16_bf16 v[88:103], v[72:75], a[232:235], v[88:103]
    ds_read_b128 v[64:67], v11 offset:34816
    ds_read_b128 v[68:71], v11 offset:35840
    v_lshlrev_b32 v17, 16, v17
    v_mfma_f32_32x32x16_bf16 v[104:119], v[76:79], a[232:235], v[104:119]
    v_add_f32 v17, 0x3727c5ac, v17
    v_cvt_pk_bf16_f32 v17, v17, v17
    s_waitcnt vmcnt(14) lgkmcnt(4)
    v_mfma_f32_32x32x16_bf16 v[88:103], v[80:83], a[236:239], v[88:103]
    ds_read_b128 v[72:75], v11 offset:36864
    ds_read_b128 v[76:79], v11 offset:37888
    v_lshlrev_b32 v17, 16, v17
    v_mfma_f32_32x32x16_bf16 v[104:119], v[84:87], a[236:239], v[104:119]
    v_sqrt_f32 v17, v17
    s_nop 0
    v_cvt_pk_bf16_f32 v17, v17, v17
    s_waitcnt vmcnt(13) lgkmcnt(4)
    v_mfma_f32_32x32x16_bf16 v[88:103], v[56:59], a[240:243], v[88:103]
    ds_read_b128 v[80:83], v11 offset:38912
    ds_read_b128 v[84:87], v11 offset:39936
    v_lshlrev_b32 v17, 16, v17
    v_mfma_f32_32x32x16_bf16 v[104:119], v[60:63], a[240:243], v[104:119]
    v_rcp_f32 v26, v17
    s_nop 0
    v_mul_f32 v26, v26, v26
    s_waitcnt vmcnt(11) lgkmcnt(4)
    s_barrier
    v_mfma_f32_32x32x16_bf16 v[88:103], v[64:67], a[244:247], v[88:103]
    ds_read_b128 v[56:59], v10 offset:0
    ds_read_b128 v[60:63], v10 offset:1024
    v_cndmask_b32 v24, 0, v24, vcc
    v_mov_b32 v27, v26
    v_mfma_f32_32x32x16_bf16 v[104:119], v[68:71], a[244:247], v[104:119]
    v_perm_b32 v28, v24, v24, s61
    s_add_u32 m0, s59, 61440
    s_nop 0
    buffer_load_dwordx4 v6, s[12:15], s16 offen offset:0 sc1 lds
    s_waitcnt vmcnt(9) lgkmcnt(4)
    v_mfma_f32_32x32x16_bf16 v[88:103], v[72:75], a[248:251], v[88:103]
    ds_read_b128 v[64:67], v10 offset:2048
    ds_read_b128 v[68:71], v10 offset:3072
    v_lshrrev_b32 v29, 16, v24
    v_mfma_f32_32x32x16_bf16 v[104:119], v[76:79], a[248:251], v[104:119]
    buffer_load_dwordx4 v6, s[12:15], s16 offen offset:1024 sc1 lds
    buffer_load_dwordx4 v6, s[12:15], s16 offen offset:2048 sc1 lds
    v_mfma_f32_32x32x16_bf16 v[88:103], v[32:35], v[28:31], v[88:103]
    v_mfma_f32_32x32x16_bf16 v[104:119], v[36:39], v[28:31], v[104:119]
    s_waitcnt vmcnt(9) lgkmcnt(4)
    v_mfma_f32_32x32x16_bf16 v[88:103], v[80:83], a[252:255], v[88:103]
    ds_read_b128 v[72:75], v10 offset:4096
    ds_read_b128 v[76:79], v10 offset:5120
    buffer_load_dwordx4 v6, s[12:15], s16 offen offset:3072 sc1 lds
    v_mfma_f32_32x32x16_bf16 v[104:119], v[84:87], a[252:255], v[104:119]
    s_add_u32 m0, s59, 65536
    s_waitcnt lgkmcnt(4)
    v_mfma_f32_32x32x16_bf16 v[120:135], v[56:59], a[96:99], 0
    ds_read_b128 v[80:83], v10 offset:6144
    ds_read_b128 v[84:87], v10 offset:7168
    buffer_load_dwordx4 v7, s[12:15], s16 offen offset:0 sc1 lds
    v_mfma_f32_32x32x16_bf16 v[136:151], v[60:63], a[96:99], 0
    s_add_u32 s16, s16, 20480
    s_waitcnt lgkmcnt(4)
    v_mfma_f32_32x32x16_bf16 v[120:135], v[64:67], a[100:103], v[120:135]
    ds_read_b128 v[56:59], v10 offset:8192
    ds_read_b128 v[60:63], v10 offset:9216
    v_mul_f32 v88, v26, v88
    v_mul_f32 v89, v26, v89
    v_mfma_f32_32x32x16_bf16 v[136:151], v[68:71], a[100:103], v[136:151]
    v_mul_f32 v90, v26, v90
    v_mul_f32 v91, v26, v91
    v_mul_f32 v92, v26, v92
    s_waitcnt lgkmcnt(4)
    v_mfma_f32_32x32x16_bf16 v[120:135], v[72:75], a[104:107], v[120:135]
    ds_read_b128 v[64:67], v10 offset:10240
    ds_read_b128 v[68:71], v10 offset:11264
    v_mul_f32 v93, v26, v93
    v_mul_f32 v94, v26, v94
    v_mfma_f32_32x32x16_bf16 v[136:151], v[76:79], a[104:107], v[136:151]
    v_mul_f32 v95, v26, v95
    v_mul_f32 v88, v104, v88
    v_mul_f32 v89, v105, v89
    s_waitcnt lgkmcnt(4)
    v_mfma_f32_32x32x16_bf16 v[120:135], v[80:83], a[108:111], v[120:135]
    ds_read_b128 v[72:75], v10 offset:12288
    ds_read_b128 v[76:79], v10 offset:13312
    v_mul_f32 v90, v106, v90
    v_mul_f32 v91, v107, v91
    v_mfma_f32_32x32x16_bf16 v[136:151], v[84:87], a[108:111], v[136:151]
    v_mul_f32 v92, v108, v92
    v_mul_f32 v93, v109, v93
    v_mul_f32 v94, v110, v94
    s_waitcnt lgkmcnt(4)
    v_mfma_f32_32x32x16_bf16 v[120:135], v[56:59], a[112:115], v[120:135]
    ds_read_b128 v[80:83], v10 offset:14336
    ds_read_b128 v[84:87], v10 offset:15360
    v_mul_f32 v95, v111, v95
    v_cvt_pk_bf16_f32 v88, v88, v89
    v_mfma_f32_32x32x16_bf16 v[136:151], v[60:63], a[112:115], v[136:151]
    v_cvt_pk_bf16_f32 v89, v90, v91
    v_cvt_pk_bf16_f32 v90, v92, v93
    v_cvt_pk_bf16_f32 v91, v94, v95
    s_waitcnt lgkmcnt(4)
    v_mfma_f32_32x32x16_bf16 v[120:135], v[64:67], a[116:119], v[120:135]
    ds_read_b128 v[56:59], v10 offset:16384
    ds_read_b128 v[60:63], v10 offset:17408
    buffer_store_dwordx4 v[88:91], v6, s[44:47], s4 offen offset:0 sc1
    v_mul_f32 v96, v26, v96
    v_mfma_f32_32x32x16_bf16 v[136:151], v[68:71], a[116:119], v[136:151]
    v_mul_f32 v97, v26, v97
    v_mul_f32 v98, v26, v98
    v_mul_f32 v99, v26, v99
    s_waitcnt lgkmcnt(4)
    v_mfma_f32_32x32x16_bf16 v[120:135], v[72:75], a[120:123], v[120:135]
    ds_read_b128 v[64:67], v10 offset:18432
    ds_read_b128 v[68:71], v10 offset:19456
    v_mul_f32 v100, v26, v100
    v_mul_f32 v101, v26, v101
    v_mfma_f32_32x32x16_bf16 v[136:151], v[76:79], a[120:123], v[136:151]
    v_mul_f32 v102, v26, v102
    v_mul_f32 v103, v26, v103
    v_mul_f32 v96, v112, v96
    s_waitcnt vmcnt(11) lgkmcnt(4)
    s_barrier
    v_mfma_f32_32x32x16_bf16 v[120:135], v[80:83], a[124:127], v[120:135]
    ds_read_b128 v[72:75], v10 offset:20480
    ds_read_b128 v[76:79], v10 offset:21504
    s_add_u32 m0, s59, 81920
    s_nop 0
    buffer_load_dwordx4 v6, s[12:15], s16 offen offset:0 sc1 lds
    v_mfma_f32_32x32x16_bf16 v[136:151], v[84:87], a[124:127], v[136:151]
    v_mul_f32 v97, v113, v97
    v_mul_f32 v98, v114, v98
    v_mul_f32 v99, v115, v99
    v_mul_f32 v100, v116, v100
    v_mul_f32 v101, v117, v101
    s_waitcnt lgkmcnt(4)
    v_mfma_f32_32x32x16_bf16 v[120:135], v[56:59], a[128:131], v[120:135]
    ds_read_b128 v[80:83], v10 offset:22528
    ds_read_b128 v[84:87], v10 offset:23552
    buffer_load_dwordx4 v6, s[12:15], s16 offen offset:1024 sc1 lds
    buffer_load_dwordx4 v6, s[12:15], s16 offen offset:2048 sc1 lds
    v_mfma_f32_32x32x16_bf16 v[136:151], v[60:63], a[128:131], v[136:151]
    v_mul_f32 v102, v118, v102
    v_mul_f32 v103, v119, v103
    v_cvt_pk_bf16_f32 v96, v96, v97
    v_cvt_pk_bf16_f32 v97, v98, v99
    v_cvt_pk_bf16_f32 v98, v100, v101
    s_waitcnt lgkmcnt(4)
    v_mfma_f32_32x32x16_bf16 v[120:135], v[64:67], a[132:135], v[120:135]
    ds_read_b128 v[56:59], v10 offset:24576
    ds_read_b128 v[60:63], v10 offset:25600
    buffer_load_dwordx4 v6, s[12:15], s16 offen offset:3072 sc1 lds
    s_add_u32 m0, s59, 86016
    v_mfma_f32_32x32x16_bf16 v[136:151], v[68:71], a[132:135], v[136:151]
    v_cvt_pk_bf16_f32 v99, v102, v103
    buffer_store_dwordx4 v[96:99], v6, s[44:47], s4 offen offset:1024 sc1
    s_add_u32 s4, s4, 2048
    s_waitcnt lgkmcnt(4)
    v_mfma_f32_32x32x16_bf16 v[120:135], v[72:75], a[136:139], v[120:135]
    ds_read_b128 v[64:67], v10 offset:26624
    ds_read_b128 v[68:71], v10 offset:27648
    buffer_load_dwordx4 v7, s[12:15], s16 offen offset:0 sc1 lds
    v_mfma_f32_32x32x16_bf16 v[136:151], v[76:79], a[136:139], v[136:151]
    s_add_u32 s16, s16, 20480
    s_waitcnt lgkmcnt(4)
    v_mfma_f32_32x32x16_bf16 v[120:135], v[80:83], a[140:143], v[120:135]
    ds_read_b128 v[72:75], v10 offset:28672
    ds_read_b128 v[76:79], v10 offset:29696
    v_mfma_f32_32x32x16_bf16 v[136:151], v[84:87], a[140:143], v[136:151]
    s_waitcnt lgkmcnt(4)
    v_mfma_f32_32x32x16_bf16 v[120:135], v[56:59], a[144:147], v[120:135]
    ds_read_b128 v[80:83], v10 offset:30720
    ds_read_b128 v[84:87], v10 offset:31744
    s_add_u32 s30, s58, 10240
    v_mfma_f32_32x32x16_bf16 v[136:151], v[60:63], a[144:147], v[136:151]
    s_add_u32 m0, s29, 0
    s_waitcnt lgkmcnt(4)
    v_mfma_f32_32x32x16_bf16 v[120:135], v[64:67], a[148:151], v[120:135]
    ds_read_b128 v[56:59], v10 offset:32768
    ds_read_b128 v[60:63], v10 offset:33792
    buffer_load_dwordx4 v6, s[36:39], s30 offen offset:0 sc1 lds
    v_mfma_f32_32x32x16_bf16 v[136:151], v[68:71], a[148:151], v[136:151]
    buffer_load_dwordx4 v6, s[36:39], s30 offen offset:1024 sc1 lds
    s_waitcnt lgkmcnt(4)
    v_mfma_f32_32x32x16_bf16 v[120:135], v[72:75], a[152:155], v[120:135]
    ds_read_b128 v[64:67], v10 offset:34816
    ds_read_b128 v[68:71], v10 offset:35840
    buffer_load_dwordx4 v6, s[36:39], s30 offen offset:2048 sc1 lds
    v_mfma_f32_32x32x16_bf16 v[136:151], v[76:79], a[152:155], v[136:151]
    buffer_load_dwordx4 v6, s[36:39], s30 offen offset:3072 sc1 lds
    s_waitcnt lgkmcnt(4)
    v_mfma_f32_32x32x16_bf16 v[120:135], v[80:83], a[156:159], v[120:135]
    ds_read_b128 v[72:75], v10 offset:36864
    ds_read_b128 v[76:79], v10 offset:37888
    s_add_u32 m0, s29, 4096
    v_mfma_f32_32x32x16_bf16 v[136:151], v[84:87], a[156:159], v[136:151]
    buffer_load_dwordx4 v7, s[36:39], s30 offen sc1 lds
    s_waitcnt lgkmcnt(4)
    v_mfma_f32_32x32x16_bf16 v[120:135], v[56:59], a[160:163], v[120:135]
    ds_read_b128 v[80:83], v10 offset:38912
    ds_read_b128 v[84:87], v10 offset:39936
    v_mfma_f32_32x32x16_bf16 v[136:151], v[60:63], a[160:163], v[136:151]
    s_waitcnt vmcnt(17) lgkmcnt(4)
    s_barrier
    v_mfma_f32_32x32x16_bf16 v[120:135], v[64:67], a[164:167], v[120:135]
    ds_read_b128 v[56:59], v10 offset:40960
    ds_read_b128 v[60:63], v10 offset:41984
    s_add_u32 m0, s59, 0
    v_mfma_f32_32x32x16_bf16 v[136:151], v[68:71], a[164:167], v[136:151]
    buffer_load_dwordx4 v6, s[12:15], s16 offen offset:0 sc1 lds
    s_waitcnt lgkmcnt(4)
    v_mfma_f32_32x32x16_bf16 v[120:135], v[72:75], a[168:171], v[120:135]
    ds_read_b128 v[64:67], v10 offset:43008
    ds_read_b128 v[68:71], v10 offset:44032
    buffer_load_dwordx4 v6, s[12:15], s16 offen offset:1024 sc1 lds
    v_mfma_f32_32x32x16_bf16 v[136:151], v[76:79], a[168:171], v[136:151]
    buffer_load_dwordx4 v6, s[12:15], s16 offen offset:2048 sc1 lds
    s_waitcnt lgkmcnt(4)
    v_mfma_f32_32x32x16_bf16 v[120:135], v[80:83], a[172:175], v[120:135]
    ds_read_b128 v[72:75], v10 offset:45056
    ds_read_b128 v[76:79], v10 offset:46080
    buffer_load_dwordx4 v6, s[12:15], s16 offen offset:3072 sc1 lds
    v_mfma_f32_32x32x16_bf16 v[136:151], v[84:87], a[172:175], v[136:151]
    s_add_u32 m0, s59, 4096
    s_waitcnt lgkmcnt(4)
    v_mfma_f32_32x32x16_bf16 v[120:135], v[56:59], a[176:179], v[120:135]
    ds_read_b128 v[80:83], v10 offset:47104
    ds_read_b128 v[84:87], v10 offset:48128
    buffer_load_dwordx4 v7, s[12:15], s16 offen offset:0 sc1 lds
    v_mfma_f32_32x32x16_bf16 v[136:151], v[60:63], a[176:179], v[136:151]
    s_add_u32 s16, s16, 20480
    s_waitcnt lgkmcnt(4)
    v_mfma_f32_32x32x16_bf16 v[120:135], v[64:67], a[180:183], v[120:135]
    ds_read_b128 v[56:59], v10 offset:49152
    ds_read_b128 v[60:63], v10 offset:50176
    v_mfma_f32_32x32x16_bf16 v[136:151], v[68:71], a[180:183], v[136:151]
    s_waitcnt lgkmcnt(4)
    v_mfma_f32_32x32x16_bf16 v[120:135], v[72:75], a[184:187], v[120:135]
    ds_read_b128 v[64:67], v10 offset:51200
    ds_read_b128 v[68:71], v10 offset:52224
    s_waitcnt vmcnt(11)
    s_mov_b64 exec, 1
    buffer_atomic_add v9, v8, s[8:11], s5 offen offset:0 sc1
    s_mov_b64 exec, -1
    v_mfma_f32_32x32x16_bf16 v[136:151], v[76:79], a[184:187], v[136:151]
    s_add_u32 s30, s58, 25600
    s_add_u32 m0, s29, 5120
    s_waitcnt lgkmcnt(4)
    v_mfma_f32_32x32x16_bf16 v[120:135], v[80:83], a[188:191], v[120:135]
    ds_read_b128 v[72:75], v10 offset:53248
    ds_read_b128 v[76:79], v10 offset:54272
    buffer_load_dwordx4 v6, s[36:39], s30 offen offset:0 sc1 lds
    v_mfma_f32_32x32x16_bf16 v[136:151], v[84:87], a[188:191], v[136:151]
    buffer_load_dwordx4 v6, s[36:39], s30 offen offset:1024 sc1 lds
    s_waitcnt lgkmcnt(4)
    v_mfma_f32_32x32x16_bf16 v[120:135], v[56:59], a[192:195], v[120:135]
    ds_read_b128 v[80:83], v10 offset:55296
    ds_read_b128 v[84:87], v10 offset:56320
    buffer_load_dwordx4 v6, s[36:39], s30 offen offset:2048 sc1 lds
    v_mfma_f32_32x32x16_bf16 v[136:151], v[60:63], a[192:195], v[136:151]
    buffer_load_dwordx4 v6, s[36:39], s30 offen offset:3072 sc1 lds
    s_waitcnt lgkmcnt(4)
    v_mfma_f32_32x32x16_bf16 v[120:135], v[64:67], a[196:199], v[120:135]
    ds_read_b128 v[56:59], v10 offset:57344
    ds_read_b128 v[60:63], v10 offset:58368
    s_add_u32 m0, s29, 9216
    v_mfma_f32_32x32x16_bf16 v[136:151], v[68:71], a[196:199], v[136:151]
    buffer_load_dwordx4 v7, s[36:39], s30 offen sc1 lds
    s_waitcnt lgkmcnt(4)
    v_mfma_f32_32x32x16_bf16 v[120:135], v[72:75], a[200:203], v[120:135]
    ds_read_b128 v[64:67], v10 offset:59392
    ds_read_b128 v[68:71], v10 offset:60416
    v_mfma_f32_32x32x16_bf16 v[136:151], v[76:79], a[200:203], v[136:151]
    s_waitcnt vmcnt(23) lgkmcnt(4)
    s_barrier
    v_mfma_f32_32x32x16_bf16 v[120:135], v[80:83], a[204:207], v[120:135]
    ds_read_b128 v[72:75], v11 offset:0
    ds_read_b128 v[76:79], v11 offset:1024
    s_add_u32 m0, s59, 20480
    v_mfma_f32_32x32x16_bf16 v[136:151], v[84:87], a[204:207], v[136:151]
    buffer_load_dwordx4 v6, s[12:15], s16 offen offset:0 sc1 lds
    s_waitcnt lgkmcnt(4)
    v_mfma_f32_32x32x16_bf16 v[120:135], v[56:59], a[208:211], v[120:135]
    ds_read_b128 v[80:83], v11 offset:2048
    ds_read_b128 v[84:87], v11 offset:3072
    buffer_load_dwordx4 v6, s[12:15], s16 offen offset:1024 sc1 lds
    v_mfma_f32_32x32x16_bf16 v[136:151], v[60:63], a[208:211], v[136:151]
    buffer_load_dwordx4 v6, s[12:15], s16 offen offset:2048 sc1 lds
    s_waitcnt lgkmcnt(4)
    v_mfma_f32_32x32x16_bf16 v[120:135], v[64:67], a[212:215], v[120:135]
    ds_read_b128 v[56:59], v11 offset:4096
    ds_read_b128 v[60:63], v11 offset:5120
    buffer_load_dwordx4 v6, s[12:15], s16 offen offset:3072 sc1 lds
    v_mfma_f32_32x32x16_bf16 v[136:151], v[68:71], a[212:215], v[136:151]
    s_add_u32 m0, s59, 24576
    s_waitcnt lgkmcnt(4)
    v_mfma_f32_32x32x16_bf16 v[120:135], v[72:75], a[216:219], v[120:135]
    ds_read_b128 v[64:67], v11 offset:6144
    ds_read_b128 v[68:71], v11 offset:7168
    buffer_load_dwordx4 v7, s[12:15], s16 offen offset:0 sc1 lds
    v_mfma_f32_32x32x16_bf16 v[136:151], v[76:79], a[216:219], v[136:151]
    s_add_u32 s16, s16, 20480
    s_waitcnt lgkmcnt(4)
    v_mfma_f32_32x32x16_bf16 v[120:135], v[80:83], a[220:223], v[120:135]
    ds_read_b128 v[72:75], v11 offset:8192
    ds_read_b128 v[76:79], v11 offset:9216
    v_mfma_f32_32x32x16_bf16 v[136:151], v[84:87], a[220:223], v[136:151]
    s_waitcnt lgkmcnt(4)
    v_mfma_f32_32x32x16_bf16 v[120:135], v[56:59], a[224:227], v[120:135]
    ds_read_b128 v[80:83], v11 offset:10240
    ds_read_b128 v[84:87], v11 offset:11264
    s_add_u32 s30, s58, 40960
    v_mfma_f32_32x32x16_bf16 v[136:151], v[60:63], a[224:227], v[136:151]
    s_add_u32 m0, s29, 10240
    s_waitcnt lgkmcnt(4)
    v_mfma_f32_32x32x16_bf16 v[120:135], v[64:67], a[228:231], v[120:135]
    ds_read_b128 v[56:59], v11 offset:12288
    ds_read_b128 v[60:63], v11 offset:13312
    buffer_load_dwordx4 v6, s[36:39], s30 offen offset:0 sc1 lds
    v_mfma_f32_32x32x16_bf16 v[136:151], v[68:71], a[228:231], v[136:151]
    buffer_load_dwordx4 v6, s[36:39], s30 offen offset:1024 sc1 lds
    s_waitcnt lgkmcnt(4)
    v_mfma_f32_32x32x16_bf16 v[120:135], v[72:75], a[232:235], v[120:135]
    ds_read_b128 v[64:67], v11 offset:14336
    ds_read_b128 v[68:71], v11 offset:15360
    buffer_load_dwordx4 v6, s[36:39], s30 offen offset:2048 sc1 lds
    v_mfma_f32_32x32x16_bf16 v[136:151], v[76:79], a[232:235], v[136:151]
    buffer_load_dwordx4 v6, s[36:39], s30 offen offset:3072 sc1 lds
    s_waitcnt lgkmcnt(4)
    v_mfma_f32_32x32x16_bf16 v[120:135], v[80:83], a[236:239], v[120:135]
    ds_read_b128 v[72:75], v11 offset:16384
    ds_read_b128 v[76:79], v11 offset:17408
    s_add_u32 m0, s29, 14336
    v_mfma_f32_32x32x16_bf16 v[136:151], v[84:87], a[236:239], v[136:151]
    buffer_load_dwordx4 v7, s[36:39], s30 offen sc1 lds
    s_waitcnt lgkmcnt(4)
    v_mfma_f32_32x32x16_bf16 v[120:135], v[56:59], a[240:243], v[120:135]
    ds_read_b128 v[80:83], v11 offset:18432
    ds_read_b128 v[84:87], v11 offset:19456
    v_mfma_f32_32x32x16_bf16 v[136:151], v[60:63], a[240:243], v[136:151]
    s_waitcnt vmcnt(26) lgkmcnt(4)
    s_barrier
    v_mfma_f32_32x32x16_bf16 v[120:135], v[64:67], a[244:247], v[120:135]
    ds_read_b128 v[56:59], v11 offset:20480
    ds_read_b128 v[60:63], v11 offset:21504
    s_add_u32 m0, s59, 40960
    v_mfma_f32_32x32x16_bf16 v[136:151], v[68:71], a[244:247], v[136:151]
    buffer_load_dwordx4 v6, s[12:15], s16 offen offset:0 sc1 lds
    s_waitcnt lgkmcnt(4)
    v_mfma_f32_32x32x16_bf16 v[120:135], v[72:75], a[248:251], v[120:135]
    ds_read_b128 v[64:67], v11 offset:22528
    ds_read_b128 v[68:71], v11 offset:23552
    buffer_load_dwordx4 v6, s[12:15], s16 offen offset:1024 sc1 lds
    v_mfma_f32_32x32x16_bf16 v[136:151], v[76:79], a[248:251], v[136:151]
    buffer_load_dwordx4 v6, s[12:15], s16 offen offset:2048 sc1 lds
    v_mfma_f32_32x32x16_bf16 v[120:135], v[40:43], v[28:31], v[120:135]
    v_mfma_f32_32x32x16_bf16 v[136:151], v[44:47], v[28:31], v[136:151]
    s_waitcnt lgkmcnt(4)
    v_mfma_f32_32x32x16_bf16 v[120:135], v[80:83], a[252:255], v[120:135]
    ds_read_b128 v[72:75], v11 offset:24576
    ds_read_b128 v[76:79], v11 offset:25600
    buffer_load_dwordx4 v6, s[12:15], s16 offen offset:3072 sc1 lds
    v_mfma_f32_32x32x16_bf16 v[136:151], v[84:87], a[252:255], v[136:151]
    s_add_u32 m0, s59, 45056
    s_waitcnt lgkmcnt(4)
    v_mfma_f32_32x32x16_bf16 v[88:103], v[56:59], a[96:99], 0
    ds_read_b128 v[80:83], v11 offset:26624
    ds_read_b128 v[84:87], v11 offset:27648
    buffer_load_dwordx4 v7, s[12:15], s16 offen offset:0 sc1 lds
    v_mfma_f32_32x32x16_bf16 v[104:119], v[60:63], a[96:99], 0
    s_add_u32 s16, s16, 20480
    s_waitcnt lgkmcnt(4)
    v_mfma_f32_32x32x16_bf16 v[88:103], v[64:67], a[100:103], v[88:103]
    ds_read_b128 v[56:59], v11 offset:28672
    ds_read_b128 v[60:63], v11 offset:29696
    v_mul_f32 v120, v26, v120
    v_mul_f32 v121, v26, v121
    v_mfma_f32_32x32x16_bf16 v[104:119], v[68:71], a[100:103], v[104:119]
    v_mul_f32 v122, v26, v122
    v_mul_f32 v123, v26, v123
    v_mul_f32 v124, v26, v124
    s_waitcnt lgkmcnt(4)
    v_mfma_f32_32x32x16_bf16 v[88:103], v[72:75], a[104:107], v[88:103]
    ds_read_b128 v[64:67], v11 offset:30720
    ds_read_b128 v[68:71], v11 offset:31744
    v_mul_f32 v125, v26, v125
    v_mul_f32 v126, v26, v126
    v_mfma_f32_32x32x16_bf16 v[104:119], v[76:79], a[104:107], v[104:119]
    v_mul_f32 v127, v26, v127
    v_mul_f32 v120, v136, v120
    v_mul_f32 v121, v137, v121
    s_waitcnt lgkmcnt(4)
    v_mfma_f32_32x32x16_bf16 v[88:103], v[80:83], a[108:111], v[88:103]
    ds_read_b128 v[72:75], v11 offset:32768
    ds_read_b128 v[76:79], v11 offset:33792
    v_mul_f32 v122, v138, v122
    v_mul_f32 v123, v139, v123
    v_mfma_f32_32x32x16_bf16 v[104:119], v[84:87], a[108:111], v[104:119]
    v_mul_f32 v124, v140, v124
    v_mul_f32 v125, v141, v125
    v_mul_f32 v126, v142, v126
    s_waitcnt lgkmcnt(4)
    v_mfma_f32_32x32x16_bf16 v[88:103], v[56:59], a[112:115], v[88:103]
    ds_read_b128 v[80:83], v11 offset:34816
    ds_read_b128 v[84:87], v11 offset:35840
    v_mul_f32 v127, v143, v127
    v_cvt_pk_bf16_f32 v120, v120, v121
    v_mfma_f32_32x32x16_bf16 v[104:119], v[60:63], a[112:115], v[104:119]
    v_cvt_pk_bf16_f32 v121, v122, v123
    v_cvt_pk_bf16_f32 v122, v124, v125
    v_cvt_pk_bf16_f32 v123, v126, v127
    s_waitcnt lgkmcnt(4)
    v_mfma_f32_32x32x16_bf16 v[88:103], v[64:67], a[116:119], v[88:103]
    ds_read_b128 v[56:59], v11 offset:36864
    ds_read_b128 v[60:63], v11 offset:37888
    buffer_store_dwordx4 v[120:123], v6, s[44:47], s4 offen offset:0 sc1
    v_mul_f32 v128, v26, v128
    v_mfma_f32_32x32x16_bf16 v[104:119], v[68:71], a[116:119], v[104:119]
    v_mul_f32 v129, v26, v129
    v_mul_f32 v130, v26, v130
    v_mul_f32 v131, v26, v131
    s_waitcnt lgkmcnt(4)
    v_mfma_f32_32x32x16_bf16 v[88:103], v[72:75], a[120:123], v[88:103]
    ds_read_b128 v[64:67], v11 offset:38912
    ds_read_b128 v[68:71], v11 offset:39936
    v_mul_f32 v132, v26, v132
    v_mul_f32 v133, v26, v133
    v_mfma_f32_32x32x16_bf16 v[104:119], v[76:79], a[120:123], v[104:119]
    v_mul_f32 v134, v26, v134
    v_mul_f32 v135, v26, v135
    v_mul_f32 v128, v144, v128
    s_waitcnt vmcnt(22) lgkmcnt(4)
    s_barrier
    v_mfma_f32_32x32x16_bf16 v[88:103], v[80:83], a[124:127], v[88:103]
    ds_read_b128 v[72:75], v10 offset:0
    ds_read_b128 v[76:79], v10 offset:1024
    v_mul_f32 v129, v145, v129
    v_mul_f32 v130, v146, v130
    v_mfma_f32_32x32x16_bf16 v[104:119], v[84:87], a[124:127], v[104:119]
    v_mul_f32 v131, v147, v131
    v_mul_f32 v132, v148, v132
    v_mul_f32 v133, v149, v133
    s_waitcnt lgkmcnt(4)
    v_mfma_f32_32x32x16_bf16 v[88:103], v[56:59], a[128:131], v[88:103]
    ds_read_b128 v[80:83], v10 offset:2048
    ds_read_b128 v[84:87], v10 offset:3072
    v_mul_f32 v134, v150, v134
    v_mul_f32 v135, v151, v135
    v_mfma_f32_32x32x16_bf16 v[104:119], v[60:63], a[128:131], v[104:119]
    v_cvt_pk_bf16_f32 v128, v128, v129
    v_cvt_pk_bf16_f32 v129, v130, v131
    v_cvt_pk_bf16_f32 v130, v132, v133
    v_mov_b32 v15, 0
    s_mov_b64 exec, 1
    buffer_atomic_add v15, v8, s[8:11], s6 offen offset:0 sc0 sc1
    s_mov_b64 exec, -1
    s_waitcnt lgkmcnt(4)
    v_mfma_f32_32x32x16_bf16 v[88:103], v[64:67], a[132:135], v[88:103]
    ds_read_b128 v[56:59], v10 offset:4096
    ds_read_b128 v[60:63], v10 offset:5120
    v_cvt_pk_bf16_f32 v131, v134, v135
    v_mfma_f32_32x32x16_bf16 v[104:119], v[68:71], a[132:135], v[104:119]
    buffer_store_dwordx4 v[128:131], v6, s[44:47], s4 offen offset:1024 sc1
    s_add_u32 s4, s4, 2048
    s_waitcnt lgkmcnt(4)
    v_mfma_f32_32x32x16_bf16 v[88:103], v[72:75], a[136:139], v[88:103]
    ds_read_b128 v[64:67], v10 offset:6144
    ds_read_b128 v[68:71], v10 offset:7168
    v_mfma_f32_32x32x16_bf16 v[104:119], v[76:79], a[136:139], v[104:119]
    s_waitcnt lgkmcnt(4)
    v_mfma_f32_32x32x16_bf16 v[88:103], v[80:83], a[140:143], v[88:103]
    ds_read_b128 v[72:75], v10 offset:8192
    ds_read_b128 v[76:79], v10 offset:9216
    v_mfma_f32_32x32x16_bf16 v[104:119], v[84:87], a[140:143], v[104:119]
    s_waitcnt lgkmcnt(4)
    v_mfma_f32_32x32x16_bf16 v[88:103], v[56:59], a[144:147], v[88:103]
    ds_read_b128 v[80:83], v10 offset:10240
    ds_read_b128 v[84:87], v10 offset:11264
    v_mfma_f32_32x32x16_bf16 v[104:119], v[60:63], a[144:147], v[104:119]
    s_waitcnt lgkmcnt(4)
    v_mfma_f32_32x32x16_bf16 v[88:103], v[64:67], a[148:151], v[88:103]
    ds_read_b128 v[56:59], v10 offset:12288
    ds_read_b128 v[60:63], v10 offset:13312
    v_mfma_f32_32x32x16_bf16 v[104:119], v[68:71], a[148:151], v[104:119]
    s_waitcnt lgkmcnt(4)
    v_mfma_f32_32x32x16_bf16 v[88:103], v[72:75], a[152:155], v[88:103]
    ds_read_b128 v[64:67], v10 offset:14336
    ds_read_b128 v[68:71], v10 offset:15360
    v_mfma_f32_32x32x16_bf16 v[104:119], v[76:79], a[152:155], v[104:119]
    s_waitcnt lgkmcnt(4)
    v_mfma_f32_32x32x16_bf16 v[88:103], v[80:83], a[156:159], v[88:103]
    ds_read_b128 v[72:75], v10 offset:16384
    ds_read_b128 v[76:79], v10 offset:17408
    v_mfma_f32_32x32x16_bf16 v[104:119], v[84:87], a[156:159], v[104:119]
    s_waitcnt lgkmcnt(4)
    v_mfma_f32_32x32x16_bf16 v[88:103], v[56:59], a[160:163], v[88:103]
    ds_read_b128 v[80:83], v10 offset:18432
    ds_read_b128 v[84:87], v10 offset:19456
    v_mfma_f32_32x32x16_bf16 v[104:119], v[60:63], a[160:163], v[104:119]
    s_waitcnt vmcnt(13) lgkmcnt(4)
    s_barrier
    v_mfma_f32_32x32x16_bf16 v[88:103], v[64:67], a[164:167], v[88:103]
    ds_read_b128 v[56:59], v10 offset:20480
    ds_read_b128 v[60:63], v10 offset:21504
    v_mfma_f32_32x32x16_bf16 v[104:119], v[68:71], a[164:167], v[104:119]
    s_waitcnt lgkmcnt(4)
    v_mfma_f32_32x32x16_bf16 v[88:103], v[72:75], a[168:171], v[88:103]
    ds_read_b128 v[64:67], v10 offset:22528
    ds_read_b128 v[68:71], v10 offset:23552
    v_mfma_f32_32x32x16_bf16 v[104:119], v[76:79], a[168:171], v[104:119]
    s_waitcnt vmcnt(1)
    v_readfirstlane_b32 s28, v15
    s_nop 1
    s_cmp_lt_u32 s28, 8
    s_cbranch_scc1 L_p5slow_0
L_p5ok_0:
    s_waitcnt lgkmcnt(4)
    v_mfma_f32_32x32x16_bf16 v[88:103], v[80:83], a[172:175], v[88:103]
    ds_read_b128 v[72:75], v10 offset:24576
    ds_read_b128 v[76:79], v10 offset:25600
    s_add_u32 s20, s56, 0
    v_mfma_f32_32x32x16_bf16 v[104:119], v[84:87], a[172:175], v[104:119]
    s_add_u32 s21, s57, 0
    s_waitcnt lgkmcnt(4)
    v_mfma_f32_32x32x16_bf16 v[88:103], v[56:59], a[176:179], v[88:103]
    ds_read_b128 v[80:83], v10 offset:26624
    ds_read_b128 v[84:87], v10 offset:27648
    buffer_load_dwordx4 a[80:83], v240, s[40:43], s20 offen sc1
    v_mfma_f32_32x32x16_bf16 v[104:119], v[60:63], a[176:179], v[104:119]
    buffer_load_dwordx4 a[84:87], v241, s[40:43], s20 offen sc1
    s_waitcnt lgkmcnt(4)
    v_mfma_f32_32x32x16_bf16 v[88:103], v[64:67], a[180:183], v[88:103]
    ds_read_b128 v[56:59], v10 offset:28672
    ds_read_b128 v[60:63], v10 offset:29696
    buffer_load_dwordx4 a[88:91], v240, s[40:43], s21 offen sc1
    v_mfma_f32_32x32x16_bf16 v[104:119], v[68:71], a[180:183], v[104:119]
    buffer_load_dwordx4 a[92:95], v241, s[40:43], s21 offen sc1
    s_waitcnt lgkmcnt(4)
    v_mfma_f32_32x32x16_bf16 v[88:103], v[72:75], a[184:187], v[88:103]
    ds_read_b128 v[64:67], v10 offset:30720
    ds_read_b128 v[68:71], v10 offset:31744
    s_waitcnt vmcnt(4)
    s_mov_b64 exec, 1
    buffer_atomic_add v9, v8, s[8:11], s5 offen offset:128 sc1
    s_mov_b64 exec, -1
    v_mfma_f32_32x32x16_bf16 v[104:119], v[76:79], a[184:187], v[104:119]
    s_add_u32 s20, s56, 6144
    s_add_u32 s21, s57, 6144
    s_waitcnt lgkmcnt(4)
    v_mfma_f32_32x32x16_bf16 v[88:103], v[80:83], a[188:191], v[88:103]
    ds_read_b128 v[72:75], v10 offset:32768
    ds_read_b128 v[76:79], v10 offset:33792
    buffer_load_dwordx4 v[120:123], v240, s[40:43], s20 offen sc1
    v_mfma_f32_32x32x16_bf16 v[104:119], v[84:87], a[188:191], v[104:119]
    buffer_load_dwordx4 v[124:127], v241, s[40:43], s20 offen sc1
    s_waitcnt lgkmcnt(4)
    v_mfma_f32_32x32x16_bf16 v[88:103], v[56:59], a[192:195], v[88:103]
    ds_read_b128 v[80:83], v10 offset:34816
    ds_read_b128 v[84:87], v10 offset:35840
    buffer_load_dwordx4 v[128:131], v240, s[40:43], s21 offen sc1
    v_mfma_f32_32x32x16_bf16 v[104:119], v[60:63], a[192:195], v[104:119]
    buffer_load_dwordx4 v[132:135], v241, s[40:43], s21 offen sc1
    s_waitcnt lgkmcnt(4)
    v_mfma_f32_32x32x16_bf16 v[88:103], v[64:67], a[196:199], v[88:103]
    ds_read_b128 v[56:59], v10 offset:36864
    ds_read_b128 v[60:63], v10 offset:37888
    s_add_u32 s20, s56, 12288
    v_mfma_f32_32x32x16_bf16 v[104:119], v[68:71], a[196:199], v[104:119]
    s_add_u32 s21, s57, 12288
    s_waitcnt lgkmcnt(4)
    v_mfma_f32_32x32x16_bf16 v[88:103], v[72:75], a[200:203], v[88:103]
    ds_read_b128 v[64:67], v10 offset:38912
    ds_read_b128 v[68:71], v10 offset:39936
    buffer_load_dwordx4 v[136:139], v240, s[40:43], s20 offen sc1
    v_mfma_f32_32x32x16_bf16 v[104:119], v[76:79], a[200:203], v[104:119]
    buffer_load_dwordx4 v[140:143], v241, s[40:43], s20 offen sc1
    s_waitcnt vmcnt(14) lgkmcnt(4)
    s_barrier
    v_mfma_f32_32x32x16_bf16 v[88:103], v[80:83], a[204:207], v[88:103]
    ds_read_b128 v[72:75], v10 offset:40960
    ds_read_b128 v[76:79], v10 offset:41984
    buffer_load_dwordx4 v[144:147], v240, s[40:43], s21 offen sc1
    v_mfma_f32_32x32x16_bf16 v[104:119], v[84:87], a[204:207], v[104:119]
    buffer_load_dwordx4 v[148:151], v241, s[40:43], s21 offen sc1
    s_waitcnt lgkmcnt(4)
    v_mfma_f32_32x32x16_bf16 v[88:103], v[56:59], a[208:211], v[88:103]
    ds_read_b128 v[80:83], v10 offset:43008
    ds_read_b128 v[84:87], v10 offset:44032
    s_add_u32 s20, s56, 18432
    v_mfma_f32_32x32x16_bf16 v[104:119], v[60:63], a[208:211], v[104:119]
    s_add_u32 s21, s57, 18432
    s_waitcnt lgkmcnt(4)
    v_mfma_f32_32x32x16_bf16 v[88:103], v[64:67], a[212:215], v[88:103]
    ds_read_b128 v[56:59], v10 offset:45056
    ds_read_b128 v[60:63], v10 offset:46080
    buffer_load_dwordx4 a[96:99], v240, s[40:43], s20 offen sc1
    v_mfma_f32_32x32x16_bf16 v[104:119], v[68:71], a[212:215], v[104:119]
    buffer_load_dwordx4 a[100:103], v241, s[40:43], s20 offen sc1
    s_waitcnt lgkmcnt(4)
    v_mfma_f32_32x32x16_bf16 v[88:103], v[72:75], a[216:219], v[88:103]
    ds_read_b128 v[64:67], v10 offset:47104
    ds_read_b128 v[68:71], v10 offset:48128
    buffer_load_dwordx4 a[104:107], v240, s[40:43], s21 offen sc1
    v_mfma_f32_32x32x16_bf16 v[104:119], v[76:79], a[216:219], v[104:119]
    buffer_load_dwordx4 a[108:111], v241, s[40:43], s21 offen sc1
    s_waitcnt lgkmcnt(4)
    v_mfma_f32_32x32x16_bf16 v[88:103], v[80:83], a[220:223], v[88:103]
    ds_read_b128 v[72:75], v10 offset:49152
    ds_read_b128 v[76:79], v10 offset:50176
    v_mfma_f32_32x32x16_bf16 v[104:119], v[84:87], a[220:223], v[104:119]
    s_waitcnt lgkmcnt(4)
    v_mfma_f32_32x32x16_bf16 v[88:103], v[56:59], a[224:227], v[88:103]
    ds_read_b128 v[80:83], v10 offset:51200
    ds_read_b128 v[84:87], v10 offset:52224
    v_mfma_f32_32x32x16_bf16 v[104:119], v[60:63], a[224:227], v[104:119]
    s_waitcnt lgkmcnt(4)
    v_mfma_f32_32x32x16_bf16 v[88:103], v[64:67], a[228:231], v[88:103]
    ds_read_b128 v[56:59], v10 offset:53248
    ds_read_b128 v[60:63], v10 offset:54272
    v_mfma_f32_32x32x16_bf16 v[104:119], v[68:71], a[228:231], v[104:119]
    s_waitcnt lgkmcnt(4)
    v_mfma_f32_32x32x16_bf16 v[88:103], v[72:75], a[232:235], v[88:103]
    ds_read_b128 v[64:67], v10 offset:55296
    ds_read_b128 v[68:71], v10 offset:56320
    v_mfma_f32_32x32x16_bf16 v[104:119], v[76:79], a[232:235], v[104:119]
    s_waitcnt lgkmcnt(4)
    v_mfma_f32_32x32x16_bf16 v[88:103], v[80:83], a[236:239], v[88:103]
    ds_read_b128 v[72:75], v10 offset:57344
    ds_read_b128 v[76:79], v10 offset:58368
    v_mfma_f32_32x32x16_bf16 v[104:119], v[84:87], a[236:239], v[104:119]
    s_waitcnt lgkmcnt(4)
    v_mfma_f32_32x32x16_bf16 v[88:103], v[56:59], a[240:243], v[88:103]
    ds_read_b128 v[80:83], v10 offset:59392
    ds_read_b128 v[84:87], v10 offset:60416
    v_mfma_f32_32x32x16_bf16 v[104:119], v[60:63], a[240:243], v[104:119]
    s_waitcnt lgkmcnt(4)
    v_mfma_f32_32x32x16_bf16 v[88:103], v[64:67], a[244:247], v[88:103]
    v_mfma_f32_32x32x16_bf16 v[104:119], v[68:71], a[244:247], v[104:119]
    s_waitcnt lgkmcnt(2)
    v_mfma_f32_32x32x16_bf16 v[88:103], v[72:75], a[248:251], v[88:103]
    v_mfma_f32_32x32x16_bf16 v[104:119], v[76:79], a[248:251], v[104:119]
    v_mfma_f32_32x32x16_bf16 v[88:103], v[48:51], v[28:31], v[88:103]
    v_mfma_f32_32x32x16_bf16 v[104:119], v[52:55], v[28:31], v[104:119]
    s_waitcnt lgkmcnt(0)
    v_mfma_f32_32x32x16_bf16 v[88:103], v[80:83], a[252:255], v[88:103]
    v_mfma_f32_32x32x16_bf16 v[104:119], v[84:87], a[252:255], v[104:119]
    v_mov_b32 v15, 0
    s_mov_b64 exec, 1
    buffer_atomic_add v15, v8, s[8:11], s6 offen offset:128 sc0 sc1
    s_mov_b64 exec, -1
    s_nop 6
    v_pk_mul_f32 v[88:89], v[88:89], v[26:27]
    v_pk_mul_f32 v[90:91], v[90:91], v[26:27]
    v_pk_mul_f32 v[92:93], v[92:93], v[26:27]
    v_pk_mul_f32 v[94:95], v[94:95], v[26:27]
    v_pk_mul_f32 v[88:89], v[88:89], v[104:105]
    v_pk_mul_f32 v[90:91], v[90:91], v[106:107]
    v_pk_mul_f32 v[92:93], v[92:93], v[108:109]
    v_pk_mul_f32 v[94:95], v[94:95], v[110:111]
    v_cvt_pk_bf16_f32 v88, v88, v89
    v_cvt_pk_bf16_f32 v89, v90, v91
    v_cvt_pk_bf16_f32 v90, v92, v93
    v_cvt_pk_bf16_f32 v91, v94, v95
    buffer_store_dwordx4 v[88:91], v6, s[44:47], s4 offen offset:0 sc1
    v_pk_mul_f32 v[96:97], v[96:97], v[26:27]
    v_pk_mul_f32 v[98:99], v[98:99], v[26:27]
    v_pk_mul_f32 v[100:101], v[100:101], v[26:27]
    v_pk_mul_f32 v[102:103], v[102:103], v[26:27]
    v_pk_mul_f32 v[96:97], v[96:97], v[112:113]
    v_pk_mul_f32 v[98:99], v[98:99], v[114:115]
    v_pk_mul_f32 v[100:101], v[100:101], v[116:117]
    v_pk_mul_f32 v[102:103], v[102:103], v[118:119]
    v_cvt_pk_bf16_f32 v96, v96, v97
    v_cvt_pk_bf16_f32 v97, v98, v99
    v_cvt_pk_bf16_f32 v98, v100, v101
    v_cvt_pk_bf16_f32 v99, v102, v103
    buffer_store_dwordx4 v[96:99], v6, s[44:47], s4 offen offset:1024 sc1
    s_add_u32 s4, s4, 2048
    s_mov_b32 s44, s18
    s_mov_b32 s45, s19
    s_mov_b32 s46, 0x280000
    s_mov_b32 s47, 0x00020000
    v_lshlrev_b32 v20, 16, v228
    v_and_b32 v21, s52, v228
    v_lshlrev_b32 v22, 16, v229
    v_and_b32 v23, s52, v229
    v_lshlrev_b32 v24, 16, v230
    v_and_b32 v25, s52, v230
    v_lshlrev_b32 v26, 16, v231
    v_and_b32 v27, s52, v231
    v_lshlrev_b32 v28, 16, v232
    v_and_b32 v29, s52, v232
    v_lshlrev_b32 v30, 16, v233
    v_and_b32 v31, s52, v233
    v_lshlrev_b32 v32, 16, v234
    v_and_b32 v33, s52, v234
    v_lshlrev_b32 v34, 16, v235
    v_and_b32 v35, s52, v235
    v_lshlrev_b32 v36, 16, v236
    v_and_b32 v37, s52, v236
    v_lshlrev_b32 v38, 16, v237
    v_and_b32 v39, s52, v237
    s_waitcnt vmcnt(16)
    v_mfma_f32_16x16x32_bf16 v[40:43], a[0:3], a[80:83], 0
    s_add_u32 s30, s58, 56320
    buffer_load_dwordx4 a[236:239], v6, s[36:39], s30 offen offset:0 sc1
    v_mfma_f32_16x16x32_bf16 v[60:63], a[0:3], a[84:87], 0
    buffer_load_dwordx4 a[240:243], v6, s[36:39], s30 offen offset:1024 sc1
    buffer_load_dwordx4 a[244:247], v6, s[36:39], s30 offen offset:2048 sc1
    v_mfma_f32_16x16x32_bf16 v[80:83], a[0:3], a[88:91], 0
    buffer_load_dwordx4 a[248:251], v6, s[36:39], s30 offen offset:3072 sc1
    buffer_load_dwordx4 a[252:255], v7, s[36:39], s30 offen sc1
    v_mfma_f32_16x16x32_bf16 v[100:103], a[0:3], a[92:95], 0
    v_mfma_f32_16x16x32_bf16 v[44:47], a[4:7], a[80:83], 0
    v_mfma_f32_16x16x32_bf16 v[64:67], a[4:7], a[84:87], 0
    v_mfma_f32_16x16x32_bf16 v[84:87], a[4:7], a[88:91], 0
    v_mfma_f32_16x16x32_bf16 v[104:107], a[4:7], a[92:95], 0
    v_mfma_f32_16x16x32_bf16 v[48:51], a[8:11], a[80:83], 0
    v_mfma_f32_16x16x32_bf16 v[68:71], a[8:11], a[84:87], 0
    v_mfma_f32_16x16x32_bf16 v[88:91], a[8:11], a[88:91], 0
    v_mfma_f32_16x16x32_bf16 v[108:111], a[8:11], a[92:95], 0
    v_mfma_f32_16x16x32_bf16 v[52:55], a[12:15], a[80:83], 0
    v_mfma_f32_16x16x32_bf16 v[72:75], a[12:15], a[84:87], 0
    v_mfma_f32_16x16x32_bf16 v[92:95], a[12:15], a[88:91], 0
    v_mfma_f32_16x16x32_bf16 v[112:115], a[12:15], a[92:95], 0
    v_mfma_f32_16x16x32_bf16 v[56:59], a[16:19], a[80:83], 0
    v_mfma_f32_16x16x32_bf16 v[76:79], a[16:19], a[84:87], 0
    v_mfma_f32_16x16x32_bf16 v[96:99], a[16:19], a[88:91], 0
    v_mfma_f32_16x16x32_bf16 v[116:119], a[16:19], a[92:95], 0
    s_waitcnt vmcnt(16)
    v_mfma_f32_16x16x32_bf16 v[40:43], a[20:23], v[120:123], v[40:43]
    s_waitcnt vmcnt(7)
    v_readfirstlane_b32 s28, v15
    s_nop 1
    s_cmp_lt_u32 s28, 8
    s_cbranch_scc1 L_p5slow_1
L_p5ok_1:
    s_add_u32 s20, s56, 2048
    v_mfma_f32_16x16x32_bf16 v[60:63], a[20:23], v[124:127], v[60:63]
    s_add_u32 s21, s57, 2048
    buffer_load_dwordx4 a[112:115], v240, s[40:43], s20 offen sc1
    v_mfma_f32_16x16x32_bf16 v[80:83], a[20:23], v[128:131], v[80:83]
    buffer_load_dwordx4 a[116:119], v241, s[40:43], s20 offen sc1
    buffer_load_dwordx4 a[120:123], v240, s[40:43], s21 offen sc1
    v_mfma_f32_16x16x32_bf16 v[100:103], a[20:23], v[132:135], v[100:103]
    buffer_load_dwordx4 a[124:127], v241, s[40:43], s21 offen sc1
    s_add_u32 s20, s56, 8192
    v_mfma_f32_16x16x32_bf16 v[44:47], a[24:27], v[120:123], v[44:47]
    s_add_u32 s21, s57, 8192
    buffer_load_dwordx4 a[128:131], v240, s[40:43], s20 offen sc1
    v_mfma_f32_16x16x32_bf16 v[64:67], a[24:27], v[124:127], v[64:67]
    buffer_load_dwordx4 a[132:135], v241, s[40:43], s20 offen sc1
    buffer_load_dwordx4 a[136:139], v240, s[40:43], s21 offen sc1
    v_mfma_f32_16x16x32_bf16 v[84:87], a[24:27], v[128:131], v[84:87]
    buffer_load_dwordx4 a[140:143], v241, s[40:43], s21 offen sc1
    s_waitcnt vmcnt(13)
    s_mov_b64 exec, 1
    buffer_atomic_add v9, v8, s[8:11], s5 offen offset:256 sc1
    s_mov_b64 exec, -1
    v_mfma_f32_16x16x32_bf16 v[104:107], a[24:27], v[132:135], v[104:107]
    v_mfma_f32_16x16x32_bf16 v[48:51], a[28:31], v[120:123], v[48:51]
    v_mfma_f32_16x16x32_bf16 v[68:71], a[28:31], v[124:127], v[68:71]
    v_mfma_f32_16x16x32_bf16 v[88:91], a[28:31], v[128:131], v[88:91]
    v_mfma_f32_16x16x32_bf16 v[108:111], a[28:31], v[132:135], v[108:111]
    v_mfma_f32_16x16x32_bf16 v[52:55], a[32:35], v[120:123], v[52:55]
    v_mfma_f32_16x16x32_bf16 v[72:75], a[32:35], v[124:127], v[72:75]
    v_mfma_f32_16x16x32_bf16 v[92:95], a[32:35], v[128:131], v[92:95]
    v_mfma_f32_16x16x32_bf16 v[112:115], a[32:35], v[132:135], v[112:115]
    v_mfma_f32_16x16x32_bf16 v[56:59], a[36:39], v[120:123], v[56:59]
    v_mfma_f32_16x16x32_bf16 v[76:79], a[36:39], v[124:127], v[76:79]
    v_mfma_f32_16x16x32_bf16 v[96:99], a[36:39], v[128:131], v[96:99]
    v_mfma_f32_16x16x32_bf16 v[116:119], a[36:39], v[132:135], v[116:119]
    s_waitcnt vmcnt(21)
    v_mfma_f32_16x16x32_bf16 v[40:43], a[40:43], v[136:139], v[40:43]
    s_add_u32 s20, s56, 14336
    s_add_u32 s21, s57, 14336
    v_mfma_f32_16x16x32_bf16 v[60:63], a[40:43], v[140:143], v[60:63]
    buffer_load_dwordx4 a[144:147], v240, s[40:43], s20 offen sc1
    buffer_load_dwordx4 a[148:151], v241, s[40:43], s20 offen sc1
    v_mfma_f32_16x16x32_bf16 v[80:83], a[40:43], v[144:147], v[80:83]
    buffer_load_dwordx4 a[152:155], v240, s[40:43], s21 offen sc1
    buffer_load_dwordx4 a[156:159], v241, s[40:43], s21 offen sc1
    v_mfma_f32_16x16x32_bf16 v[100:103], a[40:43], v[148:151], v[100:103]
    s_add_u32 s20, s56, 20480
    s_add_u32 s21, s57, 20480
    v_mfma_f32_16x16x32_bf16 v[44:47], a[44:47], v[136:139], v[44:47]
    buffer_load_dwordx4 a[160:163], v240, s[40:43], s20 offen sc1
    buffer_load_dwordx4 a[164:167], v241, s[40:43], s20 offen sc1
    v_mfma_f32_16x16x32_bf16 v[64:67], a[44:47], v[140:143], v[64:67]
    buffer_load_dwordx4 a[168:171], v240, s[40:43], s21 offen sc1
    buffer_load_dwordx4 a[172:175], v241, s[40:43], s21 offen sc1
    v_mfma_f32_16x16x32_bf16 v[84:87], a[44:47], v[144:147], v[84:87]
    v_mfma_f32_16x16x32_bf16 v[104:107], a[44:47], v[148:151], v[104:107]
    v_mfma_f32_16x16x32_bf16 v[48:51], a[48:51], v[136:139], v[48:51]
    v_mfma_f32_16x16x32_bf16 v[68:71], a[48:51], v[140:143], v[68:71]
    v_mfma_f32_16x16x32_bf16 v[88:91], a[48:51], v[144:147], v[88:91]
    v_mfma_f32_16x16x32_bf16 v[108:111], a[48:51], v[148:151], v[108:111]
    v_mfma_f32_16x16x32_bf16 v[52:55], a[52:55], v[136:139], v[52:55]
    v_mfma_f32_16x16x32_bf16 v[72:75], a[52:55], v[140:143], v[72:75]
    v_mfma_f32_16x16x32_bf16 v[92:95], a[52:55], v[144:147], v[92:95]
    v_mfma_f32_16x16x32_bf16 v[112:115], a[52:55], v[148:151], v[112:115]
    v_mfma_f32_16x16x32_bf16 v[56:59], a[56:59], v[136:139], v[56:59]
    v_mfma_f32_16x16x32_bf16 v[76:79], a[56:59], v[140:143], v[76:79]
    v_mfma_f32_16x16x32_bf16 v[96:99], a[56:59], v[144:147], v[96:99]
    v_mfma_f32_16x16x32_bf16 v[116:119], a[56:59], v[148:151], v[116:119]
    s_waitcnt vmcnt(25)
    v_mfma_f32_16x16x32_bf16 v[40:43], a[60:63], a[96:99], v[40:43]
    ds_read_b128 a[176:179], v244 offset:0
    ds_read_b128 a[180:183], v244 offset:1024
    v_mfma_f32_16x16x32_bf16 v[60:63], a[60:63], a[100:103], v[60:63]
    ds_read_b128 a[184:187], v244 offset:2048
    ds_read_b128 a[188:191], v244 offset:3072
    v_mfma_f32_16x16x32_bf16 v[80:83], a[60:63], a[104:107], v[80:83]
    ds_read_b128 a[192:195], v244 offset:4096
    v_mfma_f32_16x16x32_bf16 v[100:103], a[60:63], a[108:111], v[100:103]
    v_mfma_f32_16x16x32_bf16 v[44:47], a[64:67], a[96:99], v[44:47]
    v_mfma_f32_16x16x32_bf16 v[64:67], a[64:67], a[100:103], v[64:67]
    v_mfma_f32_16x16x32_bf16 v[84:87], a[64:67], a[104:107], v[84:87]
    v_mfma_f32_16x16x32_bf16 v[104:107], a[64:67], a[108:111], v[104:107]
    v_mfma_f32_16x16x32_bf16 v[48:51], a[68:71], a[96:99], v[48:51]
    v_mfma_f32_16x16x32_bf16 v[68:71], a[68:71], a[100:103], v[68:71]
    v_mfma_f32_16x16x32_bf16 v[88:91], a[68:71], a[104:107], v[88:91]
    v_mfma_f32_16x16x32_bf16 v[108:111], a[68:71], a[108:111], v[108:111]
    v_mfma_f32_16x16x32_bf16 v[52:55], a[72:75], a[96:99], v[52:55]
    v_mfma_f32_16x16x32_bf16 v[72:75], a[72:75], a[100:103], v[72:75]
    v_mfma_f32_16x16x32_bf16 v[92:95], a[72:75], a[104:107], v[92:95]
    v_mfma_f32_16x16x32_bf16 v[112:115], a[72:75], a[108:111], v[112:115]
    v_mfma_f32_16x16x32_bf16 v[56:59], a[76:79], a[96:99], v[56:59]
    v_mfma_f32_16x16x32_bf16 v[76:79], a[76:79], a[100:103], v[76:79]
    v_mfma_f32_16x16x32_bf16 v[96:99], a[76:79], a[104:107], v[96:99]
    v_mfma_f32_16x16x32_bf16 v[116:119], a[76:79], a[108:111], v[116:119]
    s_waitcnt vmcnt(13)
    v_mfma_f32_16x16x32_bf16 v[40:43], v[152:155], a[112:115], v[40:43]
    ds_read_b128 a[196:199], v244 offset:5120
    ds_read_b128 a[200:203], v244 offset:6144
    v_mfma_f32_16x16x32_bf16 v[60:63], v[152:155], a[116:119], v[60:63]
    ds_read_b128 a[204:207], v244 offset:7168
    ds_read_b128 a[208:211], v244 offset:8192
    v_mfma_f32_16x16x32_bf16 v[80:83], v[152:155], a[120:123], v[80:83]
    ds_read_b128 a[212:215], v244 offset:9216
    v_mov_b32 v15, 0
    s_mov_b64 exec, 1
    buffer_atomic_add v15, v8, s[8:11], s6 offen offset:256 sc0 sc1
    s_mov_b64 exec, -1
    v_mfma_f32_16x16x32_bf16 v[100:103], v[152:155], a[124:127], v[100:103]
    v_mfma_f32_16x16x32_bf16 v[44:47], v[156:159], a[112:115], v[44:47]
    v_mfma_f32_16x16x32_bf16 v[64:67], v[156:159], a[116:119], v[64:67]
    v_mfma_f32_16x16x32_bf16 v[84:87], v[156:159], a[120:123], v[84:87]
    v_mfma_f32_16x16x32_bf16 v[104:107], v[156:159], a[124:127], v[104:107]
    v_mfma_f32_16x16x32_bf16 v[48:51], v[160:163], a[112:115], v[48:51]
    v_mfma_f32_16x16x32_bf16 v[68:71], v[160:163], a[116:119], v[68:71]
    v_mfma_f32_16x16x32_bf16 v[88:91], v[160:163], a[120:123], v[88:91]
    v_mfma_f32_16x16x32_bf16 v[108:111], v[160:163], a[124:127], v[108:111]
    v_mfma_f32_16x16x32_bf16 v[52:55], v[164:167], a[112:115], v[52:55]
    v_mfma_f32_16x16x32_bf16 v[72:75], v[164:167], a[116:119], v[72:75]
    v_mfma_f32_16x16x32_bf16 v[92:95], v[164:167], a[120:123], v[92:95]
    v_mfma_f32_16x16x32_bf16 v[112:115], v[164:167], a[124:127], v[112:115]
    v_mfma_f32_16x16x32_bf16 v[56:59], v[168:171], a[112:115], v[56:59]
    v_mfma_f32_16x16x32_bf16 v[76:79], v[168:171], a[116:119], v[76:79]
    v_mfma_f32_16x16x32_bf16 v[96:99], v[168:171], a[120:123], v[96:99]
    v_mfma_f32_16x16x32_bf16 v[116:119], v[168:171], a[124:127], v[116:119]
    s_waitcnt vmcnt(10)
    v_mfma_f32_16x16x32_bf16 v[40:43], v[172:175], a[128:131], v[40:43]
    ds_read_b128 a[216:219], v244 offset:10240
    ds_read_b128 a[220:223], v244 offset:11264
    v_mfma_f32_16x16x32_bf16 v[60:63], v[172:175], a[132:135], v[60:63]
    ds_read_b128 a[224:227], v244 offset:12288
    ds_read_b128 a[228:231], v244 offset:13312
    v_mfma_f32_16x16x32_bf16 v[80:83], v[172:175], a[136:139], v[80:83]
    ds_read_b128 a[232:235], v244 offset:14336
    v_mfma_f32_16x16x32_bf16 v[100:103], v[172:175], a[140:143], v[100:103]
    v_mfma_f32_16x16x32_bf16 v[44:47], v[176:179], a[128:131], v[44:47]
    v_mfma_f32_16x16x32_bf16 v[64:67], v[176:179], a[132:135], v[64:67]
    v_mfma_f32_16x16x32_bf16 v[84:87], v[176:179], a[136:139], v[84:87]
    v_mfma_f32_16x16x32_bf16 v[104:107], v[176:179], a[140:143], v[104:107]
    v_mfma_f32_16x16x32_bf16 v[48:51], v[180:183], a[128:131], v[48:51]
    v_mfma_f32_16x16x32_bf16 v[68:71], v[180:183], a[132:135], v[68:71]
    v_mfma_f32_16x16x32_bf16 v[88:91], v[180:183], a[136:139], v[88:91]
    v_mfma_f32_16x16x32_bf16 v[108:111], v[180:183], a[140:143], v[108:111]
    v_mfma_f32_16x16x32_bf16 v[52:55], v[184:187], a[128:131], v[52:55]
    v_mfma_f32_16x16x32_bf16 v[72:75], v[184:187], a[132:135], v[72:75]
    v_mfma_f32_16x16x32_bf16 v[92:95], v[184:187], a[136:139], v[92:95]
    v_mfma_f32_16x16x32_bf16 v[112:115], v[184:187], a[140:143], v[112:115]
    v_mfma_f32_16x16x32_bf16 v[56:59], v[188:191], a[128:131], v[56:59]
    v_mfma_f32_16x16x32_bf16 v[76:79], v[188:191], a[132:135], v[76:79]
    v_mfma_f32_16x16x32_bf16 v[96:99], v[188:191], a[136:139], v[96:99]
    v_mfma_f32_16x16x32_bf16 v[116:119], v[188:191], a[140:143], v[116:119]
    s_waitcnt vmcnt(5)
    v_mfma_f32_16x16x32_bf16 v[40:43], v[192:195], a[144:147], v[40:43]
    s_waitcnt vmcnt(0)
    v_readfirstlane_b32 s28, v15
    s_nop 1
    s_cmp_lt_u32 s28, 8
    s_cbranch_scc1 L_p5slow_2
L_p5ok_2:
    s_add_u32 s20, s56, 4096
    v_mfma_f32_16x16x32_bf16 v[60:63], v[192:195], a[148:151], v[60:63]
    s_add_u32 s21, s57, 4096
    buffer_load_dwordx4 a[80:83], v240, s[40:43], s20 offen sc1
    v_mfma_f32_16x16x32_bf16 v[80:83], v[192:195], a[152:155], v[80:83]
    buffer_load_dwordx4 a[84:87], v241, s[40:43], s20 offen sc1
    buffer_load_dwordx4 a[88:91], v240, s[40:43], s21 offen sc1
    v_mfma_f32_16x16x32_bf16 v[100:103], v[192:195], a[156:159], v[100:103]
    buffer_load_dwordx4 a[92:95], v241, s[40:43], s21 offen sc1
    s_add_u32 s20, s56, 10240
    v_mfma_f32_16x16x32_bf16 v[44:47], v[196:199], a[144:147], v[44:47]
    s_add_u32 s21, s57, 10240
    buffer_load_dwordx4 v[120:123], v240, s[40:43], s20 offen sc1
    v_mfma_f32_16x16x32_bf16 v[64:67], v[196:199], a[148:151], v[64:67]
    buffer_load_dwordx4 v[124:127], v241, s[40:43], s20 offen sc1
    buffer_load_dwordx4 v[128:131], v240, s[40:43], s21 offen sc1
    v_mfma_f32_16x16x32_bf16 v[84:87], v[196:199], a[152:155], v[84:87]
    buffer_load_dwordx4 v[132:135], v241, s[40:43], s21 offen sc1
    v_mfma_f32_16x16x32_bf16 v[104:107], v[196:199], a[156:159], v[104:107]
    v_mfma_f32_16x16x32_bf16 v[48:51], v[200:203], a[144:147], v[48:51]
    v_mfma_f32_16x16x32_bf16 v[68:71], v[200:203], a[148:151], v[68:71]
    v_mfma_f32_16x16x32_bf16 v[88:91], v[200:203], a[152:155], v[88:91]
    v_mfma_f32_16x16x32_bf16 v[108:111], v[200:203], a[156:159], v[108:111]
    v_mfma_f32_16x16x32_bf16 v[52:55], v[204:207], a[144:147], v[52:55]
    v_mfma_f32_16x16x32_bf16 v[72:75], v[204:207], a[148:151], v[72:75]
    v_mfma_f32_16x16x32_bf16 v[92:95], v[204:207], a[152:155], v[92:95]
    v_mfma_f32_16x16x32_bf16 v[112:115], v[204:207], a[156:159], v[112:115]
    v_mfma_f32_16x16x32_bf16 v[56:59], v[208:211], a[144:147], v[56:59]
    v_mfma_f32_16x16x32_bf16 v[76:79], v[208:211], a[148:151], v[76:79]
    v_mfma_f32_16x16x32_bf16 v[96:99], v[208:211], a[152:155], v[96:99]
    v_mfma_f32_16x16x32_bf16 v[116:119], v[208:211], a[156:159], v[116:119]
    s_waitcnt vmcnt(9)
    v_mfma_f32_16x16x32_bf16 v[40:43], v[212:215], a[160:163], v[40:43]
    s_add_u32 s20, s56, 16384
    s_add_u32 s21, s57, 16384
    v_mfma_f32_16x16x32_bf16 v[60:63], v[212:215], a[164:167], v[60:63]
    buffer_load_dwordx4 v[136:139], v240, s[40:43], s20 offen sc1
    buffer_load_dwordx4 v[140:143], v241, s[40:43], s20 offen sc1
    v_mfma_f32_16x16x32_bf16 v[80:83], v[212:215], a[168:171], v[80:83]
    buffer_load_dwordx4 v[144:147], v240, s[40:43], s21 offen sc1
    buffer_load_dwordx4 v[148:151], v241, s[40:43], s21 offen sc1
    v_mfma_f32_16x16x32_bf16 v[100:103], v[212:215], a[172:175], v[100:103]
    s_add_u32 s20, s56, 22528
    s_add_u32 s21, s57, 22528
    v_mfma_f32_16x16x32_bf16 v[44:47], v[216:219], a[160:163], v[44:47]
    buffer_load_dwordx4 a[96:99], v240, s[40:43], s20 offen sc1
    buffer_load_dwordx4 a[100:103], v241, s[40:43], s20 offen sc1
    v_mfma_f32_16x16x32_bf16 v[64:67], v[216:219], a[164:167], v[64:67]
    buffer_load_dwordx4 a[104:107], v240, s[40:43], s21 offen sc1
    buffer_load_dwordx4 a[108:111], v241, s[40:43], s21 offen sc1
    v_mfma_f32_16x16x32_bf16 v[84:87], v[216:219], a[168:171], v[84:87]
    v_mfma_f32_16x16x32_bf16 v[104:107], v[216:219], a[172:175], v[104:107]
    v_mfma_f32_16x16x32_bf16 v[48:51], v[220:223], a[160:163], v[48:51]
    v_mfma_f32_16x16x32_bf16 v[68:71], v[220:223], a[164:167], v[68:71]
    v_mfma_f32_16x16x32_bf16 v[88:91], v[220:223], a[168:171], v[88:91]
    v_mfma_f32_16x16x32_bf16 v[108:111], v[220:223], a[172:175], v[108:111]
    v_mfma_f32_16x16x32_bf16 v[52:55], v[224:227], a[160:163], v[52:55]
    v_mfma_f32_16x16x32_bf16 v[72:75], v[224:227], a[164:167], v[72:75]
    v_mfma_f32_16x16x32_bf16 v[92:95], v[224:227], a[168:171], v[92:95]
    v_mfma_f32_16x16x32_bf16 v[112:115], v[224:227], a[172:175], v[112:115]
    v_mfma_f32_16x16x32_bf16 v[56:59], v[248:251], a[160:163], v[56:59]
    v_mfma_f32_16x16x32_bf16 v[76:79], v[248:251], a[164:167], v[76:79]
    v_mfma_f32_16x16x32_bf16 v[96:99], v[248:251], a[168:171], v[96:99]
    v_mfma_f32_16x16x32_bf16 v[116:119], v[248:251], a[172:175], v[116:119]
    s_waitcnt vmcnt(12) lgkmcnt(0)
    v_mfma_f32_16x16x32_bf16 v[40:43], a[176:179], a[80:83], v[40:43]
    v_mfma_f32_16x16x32_bf16 v[60:63], a[176:179], a[84:87], v[60:63]
    v_mfma_f32_16x16x32_bf16 v[80:83], a[176:179], a[88:91], v[80:83]
    v_mfma_f32_16x16x32_bf16 v[100:103], a[176:179], a[92:95], v[100:103]
    v_mfma_f32_16x16x32_bf16 v[44:47], a[180:183], a[80:83], v[44:47]
    v_mfma_f32_16x16x32_bf16 v[64:67], a[180:183], a[84:87], v[64:67]
    v_mfma_f32_16x16x32_bf16 v[84:87], a[180:183], a[88:91], v[84:87]
    v_mfma_f32_16x16x32_bf16 v[104:107], a[180:183], a[92:95], v[104:107]
    v_mfma_f32_16x16x32_bf16 v[48:51], a[184:187], a[80:83], v[48:51]
    v_mfma_f32_16x16x32_bf16 v[68:71], a[184:187], a[84:87], v[68:71]
    v_mfma_f32_16x16x32_bf16 v[88:91], a[184:187], a[88:91], v[88:91]
    v_mfma_f32_16x16x32_bf16 v[108:111], a[184:187], a[92:95], v[108:111]
    v_mfma_f32_16x16x32_bf16 v[52:55], a[188:191], a[80:83], v[52:55]
    v_mfma_f32_16x16x32_bf16 v[72:75], a[188:191], a[84:87], v[72:75]
    v_mfma_f32_16x16x32_bf16 v[92:95], a[188:191], a[88:91], v[92:95]
    v_mfma_f32_16x16x32_bf16 v[112:115], a[188:191], a[92:95], v[112:115]
    v_mfma_f32_16x16x32_bf16 v[56:59], a[192:195], a[80:83], v[56:59]
    v_mfma_f32_16x16x32_bf16 v[76:79], a[192:195], a[84:87], v[76:79]
    v_mfma_f32_16x16x32_bf16 v[96:99], a[192:195], a[88:91], v[96:99]
    v_mfma_f32_16x16x32_bf16 v[116:119], a[192:195], a[92:95], v[116:119]
    s_waitcnt vmcnt(8)
    v_mfma_f32_16x16x32_bf16 v[40:43], a[196:199], v[120:123], v[40:43]
    v_mfma_f32_16x16x32_bf16 v[60:63], a[196:199], v[124:127], v[60:63]
    v_mfma_f32_16x16x32_bf16 v[80:83], a[196:199], v[128:131], v[80:83]
    v_mfma_f32_16x16x32_bf16 v[100:103], a[196:199], v[132:135], v[100:103]
    v_mfma_f32_16x16x32_bf16 v[44:47], a[200:203], v[120:123], v[44:47]
    v_mfma_f32_16x16x32_bf16 v[64:67], a[200:203], v[124:127], v[64:67]
    v_mfma_f32_16x16x32_bf16 v[84:87], a[200:203], v[128:131], v[84:87]
    v_mfma_f32_16x16x32_bf16 v[104:107], a[200:203], v[132:135], v[104:107]
    v_mfma_f32_16x16x32_bf16 v[48:51], a[204:207], v[120:123], v[48:51]
    v_mfma_f32_16x16x32_bf16 v[68:71], a[204:207], v[124:127], v[68:71]
    v_mfma_f32_16x16x32_bf16 v[88:91], a[204:207], v[128:131], v[88:91]
    v_mfma_f32_16x16x32_bf16 v[108:111], a[204:207], v[132:135], v[108:111]
    v_mfma_f32_16x16x32_bf16 v[52:55], a[208:211], v[120:123], v[52:55]
    v_mfma_f32_16x16x32_bf16 v[72:75], a[208:211], v[124:127], v[72:75]
    v_mfma_f32_16x16x32_bf16 v[92:95], a[208:211], v[128:131], v[92:95]
    v_mfma_f32_16x16x32_bf16 v[112:115], a[208:211], v[132:135], v[112:115]
    v_mfma_f32_16x16x32_bf16 v[56:59], a[212:215], v[120:123], v[56:59]
    v_mfma_f32_16x16x32_bf16 v[76:79], a[212:215], v[124:127], v[76:79]
    v_mfma_f32_16x16x32_bf16 v[96:99], a[212:215], v[128:131], v[96:99]
    v_mfma_f32_16x16x32_bf16 v[116:119], a[212:215], v[132:135], v[116:119]
    s_waitcnt vmcnt(4)
    v_mfma_f32_16x16x32_bf16 v[40:43], a[216:219], v[136:139], v[40:43]
    v_mfma_f32_16x16x32_bf16 v[60:63], a[216:219], v[140:143], v[60:63]
    v_mfma_f32_16x16x32_bf16 v[80:83], a[216:219], v[144:147], v[80:83]
    v_mfma_f32_16x16x32_bf16 v[100:103], a[216:219], v[148:151], v[100:103]
    v_mfma_f32_16x16x32_bf16 v[44:47], a[220:223], v[136:139], v[44:47]
    v_mfma_f32_16x16x32_bf16 v[64:67], a[220:223], v[140:143], v[64:67]
    v_mfma_f32_16x16x32_bf16 v[84:87], a[220:223], v[144:147], v[84:87]
    v_mfma_f32_16x16x32_bf16 v[104:107], a[220:223], v[148:151], v[104:107]
    v_mfma_f32_16x16x32_bf16 v[48:51], a[224:227], v[136:139], v[48:51]
    v_mfma_f32_16x16x32_bf16 v[68:71], a[224:227], v[140:143], v[68:71]
    v_mfma_f32_16x16x32_bf16 v[88:91], a[224:227], v[144:147], v[88:91]
    v_mfma_f32_16x16x32_bf16 v[108:111], a[224:227], v[148:151], v[108:111]
    v_mfma_f32_16x16x32_bf16 v[52:55], a[228:231], v[136:139], v[52:55]
    v_mfma_f32_16x16x32_bf16 v[72:75], a[228:231], v[140:143], v[72:75]
    v_mfma_f32_16x16x32_bf16 v[92:95], a[228:231], v[144:147], v[92:95]
    v_mfma_f32_16x16x32_bf16 v[112:115], a[228:231], v[148:151], v[112:115]
    v_mfma_f32_16x16x32_bf16 v[56:59], a[232:235], v[136:139], v[56:59]
    v_mfma_f32_16x16x32_bf16 v[76:79], a[232:235], v[140:143], v[76:79]
    v_mfma_f32_16x16x32_bf16 v[96:99], a[232:235], v[144:147], v[96:99]
    v_mfma_f32_16x16x32_bf16 v[116:119], a[232:235], v[148:151], v[116:119]
    s_waitcnt vmcnt(0)
    v_mfma_f32_16x16x32_bf16 v[60:63], a[236:239], a[100:103], v[60:63]
    v_mfma_f32_16x16x32_bf16 v[64:67], a[240:243], a[100:103], v[64:67]
    v_mfma_f32_16x16x32_bf16 v[68:71], a[244:247], a[100:103], v[68:71]
    v_mfma_f32_16x16x32_bf16 v[72:75], a[248:251], a[100:103], v[72:75]
    v_mfma_f32_16x16x32_bf16 v[76:79], a[252:255], a[100:103], v[76:79]
    v_mfma_f32_16x16x32_bf16 v[80:83], a[236:239], a[104:107], v[80:83]
    s_nop 2
    ds_write_b128 v244, v[60:63] offset:0
    v_mfma_f32_16x16x32_bf16 v[84:87], a[240:243], a[104:107], v[84:87]
    ds_write_b128 v244, v[64:67] offset:1024
    v_mfma_f32_16x16x32_bf16 v[88:91], a[244:247], a[104:107], v[88:91]
    ds_write_b128 v244, v[68:71] offset:2048
    v_mfma_f32_16x16x32_bf16 v[92:95], a[248:251], a[104:107], v[92:95]
    ds_write_b128 v244, v[72:75] offset:3072
    v_mfma_f32_16x16x32_bf16 v[96:99], a[252:255], a[104:107], v[96:99]
    ds_write_b128 v244, v[76:79] offset:4096
    v_mfma_f32_16x16x32_bf16 v[100:103], a[236:239], a[108:111], v[100:103]
    ds_write_b128 v244, v[80:83] offset:5120
    v_mfma_f32_16x16x32_bf16 v[104:107], a[240:243], a[108:111], v[104:107]
    ds_write_b128 v244, v[84:87] offset:6144
    v_mfma_f32_16x16x32_bf16 v[108:111], a[244:247], a[108:111], v[108:111]
    ds_write_b128 v244, v[88:91] offset:7168
    v_mfma_f32_16x16x32_bf16 v[112:115], a[248:251], a[108:111], v[112:115]
    ds_write_b128 v244, v[92:95] offset:8192
    v_mfma_f32_16x16x32_bf16 v[116:119], a[252:255], a[108:111], v[116:119]
    ds_write_b128 v244, v[96:99] offset:9216
    v_mfma_f32_16x16x32_bf16 v[40:43], a[236:239], a[96:99], v[40:43]
    ds_write_b128 v244, v[100:103] offset:10240
    v_mfma_f32_16x16x32_bf16 v[44:47], a[240:243], a[96:99], v[44:47]
    ds_write_b128 v244, v[104:107] offset:11264
    v_mfma_f32_16x16x32_bf16 v[48:51], a[244:247], a[96:99], v[48:51]
    ds_write_b128 v244, v[108:111] offset:12288
    v_mfma_f32_16x16x32_bf16 v[52:55], a[248:251], a[96:99], v[52:55]
    ds_write_b128 v244, v[112:115] offset:13312
    v_mfma_f32_16x16x32_bf16 v[56:59], a[252:255], a[96:99], v[56:59]
    ds_write_b128 v244, v[116:119] offset:14336
    s_waitcnt lgkmcnt(0)
    s_barrier
    ds_read_b128 v[60:63], v245 offset:0
    ds_read_b128 v[80:83], v246 offset:5120
    ds_read_b128 v[100:103], v247 offset:10240
    ds_read_b128 v[64:67], v245 offset:1024
    ds_read_b128 v[84:87], v246 offset:6144
    ds_read_b128 v[104:107], v247 offset:11264
    ds_read_b128 v[68:71], v245 offset:2048
    ds_read_b128 v[88:91], v246 offset:7168
    ds_read_b128 v[108:111], v247 offset:12288
    ds_read_b128 v[72:75], v245 offset:3072
    ds_read_b128 v[92:95], v246 offset:8192
    ds_read_b128 v[112:115], v247 offset:13312
    ds_read_b128 v[76:79], v245 offset:4096
    ds_read_b128 v[96:99], v246 offset:9216
    ds_read_b128 v[116:119], v247 offset:14336
    v_pk_add_f32 v[40:41], v[40:41], v[20:21]
    v_pk_add_f32 v[42:43], v[42:43], v[22:23]
    v_pk_add_f32 v[44:45], v[44:45], v[24:25]
    v_pk_add_f32 v[46:47], v[46:47], v[26:27]
    v_pk_add_f32 v[48:49], v[48:49], v[28:29]
    v_pk_add_f32 v[50:51], v[50:51], v[30:31]
    v_pk_add_f32 v[52:53], v[52:53], v[32:33]
    v_pk_add_f32 v[54:55], v[54:55], v[34:35]
    v_pk_add_f32 v[56:57], v[56:57], v[36:37]
    v_pk_add_f32 v[58:59], v[58:59], v[38:39]
    s_waitcnt lgkmcnt(12)
    v_pk_add_f32 v[40:41], v[40:41], v[60:61]
    v_pk_add_f32 v[80:81], v[80:81], v[100:101]
    v_pk_add_f32 v[42:43], v[42:43], v[62:63]
    v_pk_add_f32 v[82:83], v[82:83], v[102:103]
    v_pk_add_f32 v[40:41], v[40:41], v[80:81]
    v_pk_add_f32 v[42:43], v[42:43], v[82:83]
    v_cvt_pk_bf16_f32 v228, v40, v41
    v_cvt_pk_bf16_f32 v229, v42, v43
    buffer_store_dwordx2 v[228:229], v242, s[44:47], 0 offen offset:0
    s_waitcnt lgkmcnt(9)
    v_pk_add_f32 v[44:45], v[44:45], v[64:65]
    v_pk_add_f32 v[84:85], v[84:85], v[104:105]
    v_pk_add_f32 v[46:47], v[46:47], v[66:67]
    v_pk_add_f32 v[86:87], v[86:87], v[106:107]
    v_pk_add_f32 v[44:45], v[44:45], v[84:85]
    v_pk_add_f32 v[46:47], v[46:47], v[86:87]
    v_cvt_pk_bf16_f32 v230, v44, v45
    v_cvt_pk_bf16_f32 v231, v46, v47
    buffer_store_dwordx2 v[230:231], v242, s[44:47], 0 offen offset:32
    s_waitcnt lgkmcnt(6)
    v_pk_add_f32 v[48:49], v[48:49], v[68:69]
    v_pk_add_f32 v[88:89], v[88:89], v[108:109]
    v_pk_add_f32 v[50:51], v[50:51], v[70:71]
    v_pk_add_f32 v[90:91], v[90:91], v[110:111]
    v_pk_add_f32 v[48:49], v[48:49], v[88:89]
    v_pk_add_f32 v[50:51], v[50:51], v[90:91]
    v_cvt_pk_bf16_f32 v232, v48, v49
    v_cvt_pk_bf16_f32 v233, v50, v51
    buffer_store_dwordx2 v[232:233], v242, s[44:47], 0 offen offset:64
    s_waitcnt lgkmcnt(3)
    v_pk_add_f32 v[52:53], v[52:53], v[72:73]
    v_pk_add_f32 v[92:93], v[92:93], v[112:113]
    v_pk_add_f32 v[54:55], v[54:55], v[74:75]
    v_pk_add_f32 v[94:95], v[94:95], v[114:115]
    v_pk_add_f32 v[52:53], v[52:53], v[92:93]
    v_pk_add_f32 v[54:55], v[54:55], v[94:95]
    v_cvt_pk_bf16_f32 v234, v52, v53
    v_cvt_pk_bf16_f32 v235, v54, v55
    buffer_store_dwordx2 v[234:235], v242, s[44:47], 0 offen offset:96
    s_waitcnt lgkmcnt(0)
    v_pk_add_f32 v[56:57], v[56:57], v[76:77]
    v_pk_add_f32 v[96:97], v[96:97], v[116:117]
    v_pk_add_f32 v[58:59], v[58:59], v[78:79]
    v_pk_add_f32 v[98:99], v[98:99], v[118:119]
    v_pk_add_f32 v[56:57], v[56:57], v[96:97]
    v_pk_add_f32 v[58:59], v[58:59], v[98:99]
    v_cvt_pk_bf16_f32 v236, v56, v57
    v_cvt_pk_bf16_f32 v237, v58, v59
    buffer_store_dwordx2 v[236:237], v242, s[44:47], 0 offen offset:128
L_k345_end:
    s_endpgm
L_cp_slow:
    s_mov_b32 s62, 0x20000
L_cp_slow1:
    s_sleep 32
    buffer_load_dword v251, v250, s[8:11], 0 offen sc1
    s_waitcnt vmcnt(0)
    s_sub_u32 s62, s62, 1
    s_cmp_eq_u32 s62, 0
    s_cbranch_scc1 L_cp_ok
    v_cmp_gt_u32 vcc, 60, v251
    s_nop 1
    s_cmp_lg_u64 vcc, 0
    s_cbranch_scc1 L_cp_slow1
    s_branch L_cp_ok
L_cw_slow:
    s_mov_b32 s62, 0x20000
L_cw_slow1:
    s_sleep 32
    buffer_load_dword v251, v250, s[8:11], 0 offen sc1
    s_waitcnt vmcnt(0)
    s_sub_u32 s62, s62, 1
    s_cmp_eq_u32 s62, 0
    s_cbranch_scc1 L_cw_ok
    v_cmp_gt_u32 vcc, 64, v251
    s_nop 1
    s_cmp_lg_u64 vcc, 0
    s_cbranch_scc1 L_cw_slow1
    s_branch L_cw_ok
L_inv_1:
    v_mfma_f32_32x32x16_bf16 v[40:55], a[244:247], a[248:251], v[40:55]
    s_branch L_inv_1r
L_inv_2:
    v_mfma_f32_32x32x16_bf16 v[72:87], a[244:247], a[248:251], v[72:87]
    s_branch L_inv_2r
L_inv_3:
    v_mfma_f32_32x32x16_bf16 v[88:103], a[244:247], a[248:251], v[88:103]
    s_branch L_inv_3r
L_inv_4:
    v_mfma_f32_32x32x16_bf16 v[104:119], a[244:247], a[248:251], v[104:119]
    s_branch L_inv_4r
L_inv_5:
    v_mfma_f32_32x32x16_bf16 v[120:135], a[244:247], a[248:251], v[120:135]
    s_branch L_inv_5r
L_inv_6:
    v_mfma_f32_32x32x16_bf16 v[136:151], a[244:247], a[248:251], v[136:151]
    s_branch L_inv_6r
L_inv_7:
    v_mfma_f32_32x32x16_bf16 v[152:167], a[244:247], a[248:251], v[152:167]
    s_branch L_inv_7r
L_inv_8:
    v_mfma_f32_32x32x16_bf16 v[168:183], a[244:247], a[248:251], v[168:183]
    s_branch L_inv_8r
L_inv_9:
    v_mfma_f32_32x32x16_bf16 v[184:199], a[244:247], a[248:251], v[184:199]
    s_branch L_inv_9r
L_inv_10:
    v_mfma_f32_32x32x16_bf16 v[56:71], a[244:247], a[248:251], v[56:71]
    s_branch L_inv_10r
L_inv_11:
    v_mfma_f32_32x32x16_bf16 v[200:215], a[244:247], a[248:251], v[200:215]
    s_branch L_inv_11r
L_inv_12:
    v_mfma_f32_32x32x16_bf16 v[40:55], a[244:247], a[248:251], v[40:55]
    s_branch L_inv_12r
L_inv_13:
    v_mfma_f32_32x32x16_bf16 v[72:87], a[244:247], a[248:251], v[72:87]
    s_branch L_inv_13r
L_inv_14:
    v_mfma_f32_32x32x16_bf16 v[88:103], a[244:247], a[248:251], v[88:103]
    s_branch L_inv_14r
L_inv_15:
    v_mfma_f32_32x32x16_bf16 v[104:119], a[244:247], a[248:251], v[104:119]
    s_branch L_inv_15r
L_p3slow_0:
    s_add_u32 s27, s6, 0
    s_mov_b32 s62, 0x40000
    s_mov_b64 exec, 1
L_poll_p3_0:
    v_mov_b32 v239, 0
    buffer_atomic_add v239, v8, s[8:11], s27 offen sc0 sc1
    s_sub_u32 s62, s62, 1
    s_cmp_eq_u32 s62, 0
    s_cbranch_scc1 L_polled_p3_0
    s_waitcnt vmcnt(0)
    v_readfirstlane_b32 s28, v239
    s_nop 1
    s_cmp_lt_u32 s28, 8
    s_cbranch_scc1 L_poll_p3_0
L_polled_p3_0:
    s_waitcnt vmcnt(0)
    s_mov_b64 exec, -1
    s_branch L_p3ok_0
L_p3slow_1:
    s_add_u32 s27, s6, 512
    s_mov_b32 s62, 0x40000
    s_mov_b64 exec, 1
L_poll_p3_1:
    v_mov_b32 v239, 0
    buffer_atomic_add v239, v8, s[8:11], s27 offen sc0 sc1
    s_sub_u32 s62, s62, 1
    s_cmp_eq_u32 s62, 0
    s_cbranch_scc1 L_polled_p3_1
    s_waitcnt vmcnt(0)
    v_readfirstlane_b32 s28, v239
    s_nop 1
    s_cmp_lt_u32 s28, 8
    s_cbranch_scc1 L_poll_p3_1
L_polled_p3_1:
    s_waitcnt vmcnt(0)
    s_mov_b64 exec, -1
    s_branch L_p3ok_1
L_p5slow_0:
    s_add_u32 s27, s6, 0
    s_mov_b32 s62, 0x40000
    s_mov_b64 exec, 1
L_poll_p5_0:
    v_mov_b32 v15, 0
    buffer_atomic_add v15, v8, s[8:11], s27 offen sc0 sc1
    s_sub_u32 s62, s62, 1
    s_cmp_eq_u32 s62, 0
    s_cbranch_scc1 L_polled_p5_0
    s_waitcnt vmcnt(0)
    v_readfirstlane_b32 s28, v15
    s_nop 1
    s_cmp_lt_u32 s28, 8
    s_cbranch_scc1 L_poll_p5_0
L_polled_p5_0:
    s_waitcnt vmcnt(0)
    s_mov_b64 exec, -1
    s_branch L_p5ok_0
L_p5slow_1:
    s_add_u32 s27, s6, 128
    s_mov_b32 s62, 0x40000
    s_mov_b64 exec, 1
L_poll_p5_1:
    v_mov_b32 v15, 0
    buffer_atomic_add v15, v8, s[8:11], s27 offen sc0 sc1
    s_sub_u32 s62, s62, 1
    s_cmp_eq_u32 s62, 0
    s_cbranch_scc1 L_polled_p5_1
    s_waitcnt vmcnt(0)
    v_readfirstlane_b32 s28, v15
    s_nop 1
    s_cmp_lt_u32 s28, 8
    s_cbranch_scc1 L_poll_p5_1
L_polled_p5_1:
    s_waitcnt vmcnt(0)
    s_mov_b64 exec, -1
    s_branch L_p5ok_1
L_p5slow_2:
    s_add_u32 s27, s6, 256
    s_mov_b32 s62, 0x40000
    s_mov_b64 exec, 1
L_poll_p5_2:
    v_mov_b32 v15, 0
    buffer_atomic_add v15, v8, s[8:11], s27 offen sc0 sc1
    s_sub_u32 s62, s62, 1
    s_cmp_eq_u32 s62, 0
    s_cbranch_scc1 L_polled_p5_2
    s_waitcnt vmcnt(0)
    v_readfirstlane_b32 s28, v15
    s_nop 1
    s_cmp_lt_u32 s28, 8
    s_cbranch_scc1 L_poll_p5_2
L_polled_p5_2:
    s_waitcnt vmcnt(0)
    s_mov_b64 exec, -1
    s_branch L_p5ok_2
L_code_end:

.section .rodata,"a"
.p2align 6
.amdhsa_kernel sequential_preLN__sliding_block__glu_gated_bilinear__prompt_kernel
  .amdhsa_next_free_vgpr 508
  .amdhsa_next_free_sgpr 100
  .amdhsa_accum_offset 252
  .amdhsa_group_segment_fixed_size 0
  .amdhsa_kernarg_size 80
  .amdhsa_user_sgpr_count 2
  .amdhsa_user_sgpr_kernarg_segment_ptr 1
  .amdhsa_system_sgpr_workgroup_id_x 1
.end_amdhsa_kernel
```
